```python
import torch

def _softmax(x, axis=-1):
    return torch.softmax(x, dim=axis)
def _gelu(x):
    return torch.nn.functional.gelu(x, approximate="tanh")
def _silu(x):
    return torch.nn.functional.silu(x)
def _sigmoid(x):
    return torch.sigmoid(x)
def _layernorm(x, axis=-1, eps=1e-5):
    m = x.mean(dim=axis, keepdim=True)
    v = x.var(dim=axis, keepdim=True, unbiased=False)
    return (x - m) / torch.sqrt(v + eps)
def _scatter_add(tgt, idx, src, axis=0):
    return tgt.clone().index_add_(axis, idx, src)
def _segment_sum(src, seg, n):
    out = torch.zeros((n,) + src.shape[1:], dtype=src.dtype)
    return out.index_add_(0, seg, src)
def _pad(x, pw):
    flat = tuple(v for pair in reversed(pw) for v in pair)
    return torch.nn.functional.pad(x, flat)

kernel_name = 'concat_heads__gqa_block_cached__sliding_block_cached__decode'

def setup_inputs():

    _w = (lambda a: (lambda t: t.to(torch.bfloat16) if t.is_floating_point() else t)(torch.as_tensor(a)))
    def _A_setup():
        B, Sq, D = 1, 1, 576
        Hq, Hkv, Sk, Dh = 32, 16, 32768, 128
        assert Hq % Hkv == 0, (Hq, Hkv)
        return {
            "x": _w((lambda *s: torch.randn(*s, dtype=torch.bfloat16) * 0.8)(B, Sq, D)),
            "k_cache": _w((lambda *s: torch.randn(*s, dtype=torch.bfloat16) * 1.6)(B, Hkv, Sk, Dh)),
            "v_cache": _w((lambda *s: torch.randn(*s, dtype=torch.bfloat16) * 0.2)(B, Hkv, Sk, Dh)),
            "wq": _w((lambda *s: torch.randn(*s, dtype=torch.bfloat16) * 1.6)(D, Hq * Dh) * (D ** -0.5)),
            "wo": _w((lambda *s: torch.randn(*s, dtype=torch.bfloat16) * 0.2)(Hq * Dh, D) * ((Hq * Dh) ** -0.5)),
        }
    _A_in = _A_setup()

    def _B_setup():
        B, Sq, D = 1, 1, 576
        Hq, Hkv, Sk, Dh = 32, 16, 32768, 128
        assert Hq % Hkv == 0, (Hq, Hkv)
        return {
            "x": _w((lambda *s: torch.randn(*s, dtype=torch.bfloat16) * 0.8)(B, Sq, D)),
            "k_cache": _w((lambda *s: torch.randn(*s, dtype=torch.bfloat16) * 1.6)(B, Hkv, Sk, Dh)),
            "v_cache": _w((lambda *s: torch.randn(*s, dtype=torch.bfloat16) * 0.2)(B, Hkv, Sk, Dh)),
            "wq": _w((lambda *s: torch.randn(*s, dtype=torch.bfloat16) * 1.6)(D, Hq * Dh) * (D ** -0.5)),
            "wo": _w((lambda *s: torch.randn(*s, dtype=torch.bfloat16) * 0.2)(Hq * Dh, D) * ((Hq * Dh) ** -0.5)),
        }
    _B_in = _B_setup()

    return {
        "A_x": _A_in["x"],
        "A_k_cache": _A_in["k_cache"],
        "A_v_cache": _A_in["v_cache"],
        "A_wq": _A_in["wq"],
        "A_wo": _A_in["wo"],
        "B_x": _B_in["x"],
        "B_k_cache": _B_in["k_cache"],
        "B_v_cache": _B_in["v_cache"],
        "B_wq": _B_in["wq"],
        "B_wo": _B_in["wo"],
    }

def reference(A_x, A_k_cache, A_v_cache, A_wq, A_wo, B_x, B_k_cache, B_v_cache, B_wq, B_wo):
    def _A_ref(x, k_cache, v_cache, wq, wo):
        B, Sq, D = x.shape
        Hq, Dh = 32, 128
        Hkv = k_cache.shape[1]
        rep = Hq // Hkv
        q = (lambda x, *d: x.permute(*d))((x @ wq).reshape(B, Sq, Hq, Dh), 0, 2, 1, 3)
        k = (lambda x, n, axis: torch.repeat_interleave(x, n, dim=axis))(k_cache, rep, axis=1)
        v = (lambda x, n, axis: torch.repeat_interleave(x, n, dim=axis))(v_cache, rep, axis=1)
        scores = torch.einsum("bhqd,bhkd->bhqk", q, k) * (Dh ** -0.5)
        p = _softmax(scores, axis=-1)
        o = torch.einsum("bhqk,bhkd->bhqd", p, v)
        return (lambda x, *d: x.permute(*d))(o, 0, 2, 1, 3).reshape(B, Sq, Hq * Dh) @ wo

    def _B_ref(x, k_cache, v_cache, wq, wo):
        B, Sq, D = x.shape
        Hq, Dh = 32, 128
        Hkv, Sk = k_cache.shape[1], k_cache.shape[2]
        W = min(4096, max(256, Sk // 4))
        rep = Hq // Hkv
        q = (lambda x, *d: x.permute(*d))((x @ wq).reshape(B, Sq, Hq, Dh), 0, 2, 1, 3)
        k = (lambda x, n, axis: torch.repeat_interleave(x, n, dim=axis))(k_cache[:, :, Sk - W:, :], rep, axis=1)
        v = (lambda x, n, axis: torch.repeat_interleave(x, n, dim=axis))(v_cache[:, :, Sk - W:, :], rep, axis=1)
        scores = torch.einsum("bhqd,bhkd->bhqk", q, k) * (Dh ** -0.5)
        p = _softmax(scores, axis=-1)
        o = torch.einsum("bhqk,bhkd->bhqd", p, v)
        return (lambda x, *d: x.permute(*d))(o, 0, 2, 1, 3).reshape(B, Sq, Hq * Dh) @ wo

    a = _A_ref(A_x, A_k_cache, A_v_cache, A_wq, A_wo)
    b = _B_ref(B_x, B_k_cache, B_v_cache, B_wq, B_wo)
    return torch.concatenate([a, b], axis=-1)
```

```asm
; @launch grid=(256,1,1) block=(320,1,1) lds=12288
.amdgcn_target "amdgcn-amd-amdhsa--gfx950"
.text
.globl concat_heads__gqa_block_cached__sliding_block_cached__decode_kernel
.p2align 8
.type concat_heads__gqa_block_cached__sliding_block_cached__decode_kernel,@function
concat_heads__gqa_block_cached__sliding_block_cached__decode_kernel:
  s_load_dwordx16 s[4:19], s[0:1], 0
  s_load_dwordx8 s[20:27], s[0:1], 64
  s_load_dwordx2 s[28:29], s[0:1], 96
  v_readfirstlane_b32 s30, v0
  v_and_b32 v1, 63, v0
  s_and_b32 s31, s2, 15
  s_lshr_b32 s32, s2, 4
  s_cmp_ge_u32 s32, 16
  s_cbranch_scc1 L_end
  s_lshr_b32 s30, s30, 6
  s_cmp_eq_u32 s30, 4
  s_cbranch_scc1 L_comm
  s_and_b32 s33, s32, 4
  s_add_u32 s33, s33, s30
  s_mulk_i32 s33, 72
  v_lshrrev_b32 v8, 4, v1
  v_mad_u32_u24 v8, v8, 18, s33
  v_bfe_u32 v5, v1, 3, 1
  v_add_u32 v5, v5, v8
  s_and_b32 s34, s32, 3
  s_lshl2_add_u32 s34, s31, s34
  s_lshl_b32 s34, s34, 7
  v_and_b32 v6, 7, v1
  v_lshlrev_b32 v6, 4, v6
  v_add_u32 v7, s34, v6
  v_lshl_add_u32 v14, v5, 13, v7
  s_movk_i32 s35, 0x4000
  s_cmp_ge_u32 s32, 8
  s_waitcnt lgkmcnt(0)
  s_cselect_b64 s[36:37], s[20:21], s[10:11]
  global_load_dwordx4 v[188:191], v14, s[36:37] nt
  v_add_u32 v14, s35, v14
  global_load_dwordx4 v[192:195], v14, s[36:37] nt
  v_add_u32 v14, s35, v14
  global_load_dwordx4 v[196:199], v14, s[36:37] nt
  v_add_u32 v14, s35, v14
  s_cselect_b64 s[38:39], s[14:15], s[4:5]
  v_lshlrev_b32 v8, 1, v8
  global_load_dwordx3 v[228:230], v8, s[38:39] offset:0
  global_load_dwordx3 v[232:234], v8, s[38:39] offset:12
  global_load_dwordx3 v[236:238], v8, s[38:39] offset:24
  global_load_dwordx4 v[200:203], v14, s[36:37] nt
  v_add_u32 v14, s35, v14
  global_load_dwordx4 v[204:207], v14, s[36:37] nt
  v_add_u32 v14, s35, v14
  global_load_dwordx4 v[208:211], v14, s[36:37] nt
  v_add_u32 v14, s35, v14
  s_cselect_b64 s[10:11], s[22:23], s[12:13]
  s_mov_b32 s3, s2
  s_lshl_b32 s2, s31, 4
  s_or_b32 s2, s2, s32
  v_lshlrev_b32 v4, 4, v1
  v_lshrrev_b32 v3, 4, v1
  v_lshlrev_b32 v3, 6, v3
  v_and_b32 v8, 3, v1
  v_lshl_add_u32 v3, v8, 4, v3
  s_lshl_b32 s41, s2, 2
  s_or_b32 s41, s41, s30
  s_lshl_b32 s45, s31, 23
  s_bfe_u32 s33, s41, 0x10006
  s_lshl_b32 s33, s33, 10
  s_or_b32 s45, s45, s33
  s_bfe_u32 s33, s41, 0x10002
  s_lshl_b32 s33, s33, 11
  s_or_b32 s45, s45, s33
  s_bfe_u32 s33, s41, 0x10000
  s_lshl_b32 s33, s33, 12
  s_or_b32 s45, s45, s33
  s_bfe_u32 s33, s41, 0x10004
  s_lshl_b32 s33, s33, 14
  s_or_b32 s45, s45, s33
  s_bfe_u32 s33, s41, 0x10001
  s_lshl_b32 s33, s33, 15
  s_or_b32 s45, s45, s33
  s_bfe_u32 s33, s41, 0x10005
  s_lshl_b32 s33, s33, 17
  s_or_b32 s45, s45, s33
  s_bfe_u32 s33, s41, 0x10004
  s_lshl_b32 s33, s33, 18
  s_or_b32 s45, s45, s33
  s_bfe_u32 s33, s41, 0x10000
  s_lshl_b32 s33, s33, 19
  s_or_b32 s45, s45, s33
  s_and_b32 s33, s41, 0x108
  s_bcnt1_i32_b32 s33, s33
  s_and_b32 s33, s33, 1
  s_lshl_b32 s33, s33, 21
  s_or_b32 s45, s45, s33
  v_xor_b32 v18, s45, v3
  v_bfe_i32 v7, v1, 2, 1
  v_and_b32 v7, 0x100, v7
  v_xor_b32 v18, v18, v7
  v_bfe_i32 v7, v1, 3, 1
  v_and_b32 v7, 0x200, v7
  v_xor_b32 v18, v18, v7
  v_mov_b32 v2, 0
  v_and_b32 v7, 1, v1
  v_cmp_eq_u32 vcc, 1, v7
  v_mov_b32 v56, 0x0c0c0100
  v_mov_b32 v57, 0x01000c0c
  v_mov_b32 v58, 0x0c0c0302
  v_mov_b32 v59, 0x03020c0c
  v_mov_b32 v60, 0x0c0c0c0c
  v_cndmask_b32 v56, v56, v57, vcc
  v_cndmask_b32 v58, v58, v59, vcc
  v_bfe_u32 v7, v1, 1, 2
  v_cmp_eq_u32 vcc, 0, v7
  s_nop 1
  v_cndmask_b32 v20, v60, v56, vcc
  v_cndmask_b32 v24, v60, v58, vcc
  v_cmp_eq_u32 vcc, 1, v7
  s_nop 1
  v_cndmask_b32 v21, v60, v56, vcc
  v_cndmask_b32 v25, v60, v58, vcc
  v_cmp_eq_u32 vcc, 2, v7
  s_nop 1
  v_cndmask_b32 v22, v60, v56, vcc
  v_cndmask_b32 v26, v60, v58, vcc
  v_cmp_eq_u32 vcc, 3, v7
  s_nop 1
  v_cndmask_b32 v23, v60, v56, vcc
  v_cndmask_b32 v27, v60, v58, vcc
  v_and_b32 v7, 8, v1
  v_cmp_ne_u32 vcc, 0, v7
  s_nop 1
  v_cndmask_b32 v56, v20, v24, vcc
  v_cndmask_b32 v57, v21, v25, vcc
  v_cndmask_b32 v58, v22, v26, vcc
  v_cndmask_b32 v59, v23, v27, vcc
  v_lshrrev_b32 v7, 5, v1
  v_lshlrev_b32 v7, 8, v7
  v_lshl_add_u32 v7, v6, 1, v7
  v_and_b32 v8, 16, v1
  s_lshl_b32 s34, s30, 9
  v_add3_u32 v7, v7, v8, s34
  s_mov_b32 s40, 0x3e0293ee
  s_waitcnt vmcnt(8)
  global_load_dwordx4 v[212:215], v14, s[36:37] nt
  v_add_u32 v14, 0x4000, v14
  s_waitcnt vmcnt(8)
  global_load_dwordx4 v[216:219], v14, s[36:37] nt
  v_add_u32 v14, 0x4000, v14
  s_waitcnt vmcnt(8)
  global_load_dwordx4 v[220:223], v14, s[36:37] nt
  s_barrier
  s_waitcnt vmcnt(6)
  v_perm_b32 v92, v228, v228, v56
  v_perm_b32 v93, v228, v228, v57
  v_perm_b32 v94, v228, v228, v58
  v_perm_b32 v95, v228, v228, v59
  s_nop 1
  v_mfma_f32_16x16x32_bf16 v[36:39], v[92:95], v[188:191], 0
  v_perm_b32 v96, v229, v229, v56
  v_perm_b32 v97, v229, v229, v57
  v_perm_b32 v98, v229, v229, v58
  v_perm_b32 v99, v229, v229, v59
  s_nop 1
  v_mfma_f32_16x16x32_bf16 v[36:39], v[96:99], v[192:195], v[36:39]
  v_perm_b32 v100, v230, v230, v56
  v_perm_b32 v101, v230, v230, v57
  v_perm_b32 v102, v230, v230, v58
  v_perm_b32 v103, v230, v230, v59
  s_nop 1
  v_mfma_f32_16x16x32_bf16 v[36:39], v[100:103], v[196:199], v[36:39]
  v_perm_b32 v104, v232, v232, v56
  v_perm_b32 v105, v232, v232, v57
  v_perm_b32 v106, v232, v232, v58
  v_perm_b32 v107, v232, v232, v59
  s_waitcnt vmcnt(5)
  s_nop 0
  v_mfma_f32_16x16x32_bf16 v[36:39], v[104:107], v[200:203], v[36:39]
  v_perm_b32 v108, v233, v233, v56
  v_perm_b32 v109, v233, v233, v57
  v_perm_b32 v110, v233, v233, v58
  v_perm_b32 v111, v233, v233, v59
  s_waitcnt vmcnt(4)
  global_load_dwordx4 v[124:127], v18, s[6:7] nt
  v_xor_b32 v18, 0x2000, v18
  v_mfma_f32_16x16x32_bf16 v[36:39], v[108:111], v[204:207], v[36:39]
  v_perm_b32 v112, v234, v234, v56
  v_perm_b32 v113, v234, v234, v57
  v_perm_b32 v114, v234, v234, v58
  v_perm_b32 v115, v234, v234, v59
  s_waitcnt vmcnt(4)
  global_load_dwordx4 v[128:131], v18, s[6:7] nt
  v_xor_b32 v18, 0x2400, v18
  v_mfma_f32_16x16x32_bf16 v[36:39], v[112:115], v[208:211], v[36:39]
  v_perm_b32 v116, v236, v236, v56
  v_perm_b32 v117, v236, v236, v57
  v_perm_b32 v118, v236, v236, v58
  v_perm_b32 v119, v236, v236, v59
  s_waitcnt vmcnt(4)
  global_load_dwordx4 v[132:135], v18, s[6:7] nt
  v_xor_b32 v18, 0x2000, v18
  v_mfma_f32_16x16x32_bf16 v[36:39], v[116:119], v[212:215], v[36:39]
  v_perm_b32 v120, v237, v237, v56
  v_perm_b32 v121, v237, v237, v57
  v_perm_b32 v122, v237, v237, v58
  v_perm_b32 v123, v237, v237, v59
  s_waitcnt vmcnt(4)
  global_load_dwordx4 v[136:139], v18, s[6:7] nt
  v_xor_b32 v18, 0x102400, v18
  v_mfma_f32_16x16x32_bf16 v[36:39], v[120:123], v[216:219], v[36:39]
  v_perm_b32 v92, v238, v238, v56
  v_perm_b32 v93, v238, v238, v57
  v_perm_b32 v94, v238, v238, v58
  v_perm_b32 v95, v238, v238, v59
  s_waitcnt vmcnt(4)
  global_load_dwordx4 v[140:143], v18, s[6:7] nt
  v_xor_b32 v18, 0x2000, v18
  v_mfma_f32_16x16x32_bf16 v[36:39], v[92:95], v[220:223], v[36:39]
  s_mov_b32 exec_lo, 0x00ff00ff
  s_mov_b32 exec_hi, 0xff00ff00
  v_mov_b32 v8, 1
  s_nop 4
  ds_write_b128 v7, v[36:39] offset:0
  s_mov_b64 exec, 1
  ds_add_u32 v2, v8 offset:3072
  s_mov_b64 exec, -1
  s_lshl_b32 s44, s31, 23
  s_or_b32 s44, s44, 0x700000
  s_bfe_u32 s33, s41, 0x10001
  s_lshl_b32 s33, s33, 10
  s_or_b32 s44, s44, s33
  s_bfe_u32 s33, s41, 0x10005
  s_lshl_b32 s33, s33, 11
  s_or_b32 s44, s44, s33
  s_bfe_u32 s33, s41, 0x10004
  s_lshl_b32 s33, s33, 12
  s_or_b32 s44, s44, s33
  s_bfe_u32 s33, s41, 0x10009
  s_lshl_b32 s33, s33, 13
  s_or_b32 s44, s44, s33
  s_bfe_u32 s33, s41, 0x10002
  s_lshl_b32 s33, s33, 14
  s_or_b32 s44, s44, s33
  s_bfe_u32 s33, s41, 0x10004
  s_lshl_b32 s33, s33, 15
  s_or_b32 s44, s44, s33
  s_bfe_u32 s33, s41, 0x10003
  s_lshl_b32 s33, s33, 16
  s_or_b32 s44, s44, s33
  s_bfe_u32 s33, s41, 0x10000
  s_lshl_b32 s33, s33, 18
  s_or_b32 s44, s44, s33
  s_bfe_u32 s33, s41, 0x10000
  s_lshl_b32 s33, s33, 19
  s_or_b32 s44, s44, s33
  v_and_b32 v5, 1, v1
  v_lshlrev_b32 v5, 8, v5
  v_lshrrev_b32 v7, 2, v1
  v_lshl_add_u32 v5, v7, 4, v5
  s_mov_b32 s42, 0xcccccccc
  s_mov_b32 s43, 0xcccccccc
  v_and_b32 v7, 15, v1
  v_lshlrev_b32 v7, 5, v7
  v_and_b32 v8, 16, v1
  v_add_u32 v7, v7, v8
  v_and_b32 v8, 32, v1
  v_lshlrev_b32 v8, 4, v8
  s_lshl_b32 s34, s30, 10
  v_add3_u32 v15, v7, v8, s34
  v_lshrrev_b32 v6, 5, v1
  v_lshlrev_b32 v6, 4, v6
  s_waitcnt vmcnt(4)
  global_load_dwordx4 v[144:147], v18, s[6:7] nt
  v_xor_b32 v18, 0x2400, v18
  s_waitcnt vmcnt(4)
  global_load_dwordx4 v[148:151], v18, s[6:7] nt
  v_xor_b32 v18, 0x2000, v18
  s_waitcnt vmcnt(4)
  global_load_dwordx4 v[152:155], v18, s[6:7] nt
  v_xor_b32 v18, 0x112400, v18
  s_waitcnt vmcnt(4)
  global_load_dwordx4 v[156:159], v18, s[6:7] nt
  v_xor_b32 v18, 0x2000, v18
  s_waitcnt vmcnt(4)
  global_load_dwordx4 v[160:163], v18, s[6:7] nt
  v_xor_b32 v18, 0x2400, v18
  s_waitcnt vmcnt(4)
  global_load_dwordx4 v[164:167], v18, s[6:7] nt
  v_xor_b32 v18, 0x2000, v18
  s_waitcnt vmcnt(4)
  global_load_dwordx4 v[168:171], v18, s[6:7] nt
  v_xor_b32 v18, 0x102400, v18
  s_waitcnt vmcnt(4)
  global_load_dwordx4 v[172:175], v18, s[6:7] nt
  v_xor_b32 v18, 0x2000, v18
  s_waitcnt vmcnt(4)
  global_load_dwordx4 v[176:179], v18, s[6:7] nt
  v_xor_b32 v18, 0x2400, v18
  s_waitcnt vmcnt(4)
  global_load_dwordx4 v[180:183], v18, s[6:7] nt
  v_xor_b32 v18, 0x2000, v18
  s_waitcnt vmcnt(4)
  global_load_dwordx4 v[184:187], v18, s[6:7] nt
  v_xor_b32 v18, 0x192400, v18
  s_waitcnt vmcnt(4)
  global_load_dwordx4 v[188:191], v18, s[6:7] nt
  v_xor_b32 v18, 0x2000, v18
  s_waitcnt vmcnt(4)
  global_load_dwordx4 v[192:195], v18, s[6:7] nt
  v_xor_b32 v18, 0x2400, v18
  s_waitcnt vmcnt(4)
  global_load_dwordx4 v[196:199], v18, s[6:7] nt
  v_xor_b32 v18, 0x2000, v18
  s_waitcnt vmcnt(4)
  global_load_dwordx4 v[200:203], v18, s[6:7] nt
  v_xor_b32 v18, 0x102400, v18
  s_waitcnt vmcnt(4)
  global_load_dwordx4 v[204:207], v18, s[6:7] nt
  v_xor_b32 v18, 0x2000, v18
  s_waitcnt vmcnt(4)
  global_load_dwordx4 v[208:211], v18, s[6:7] nt
  v_xor_b32 v18, 0x2400, v18
  v_mov_b32 v8, 1
  s_mov_b64 exec, 1
  ds_add_u32 v2, v8 offset:3080
  s_mov_b64 exec, -1
  s_waitcnt vmcnt(4)
  global_load_dwordx4 v[212:215], v18, s[6:7] nt
  v_xor_b32 v18, 0x2000, v18
  s_waitcnt vmcnt(4)
  global_load_dwordx4 v[216:219], v18, s[6:7] nt
  v_xor_b32 v18, 0x112400, v18
  s_waitcnt vmcnt(4)
  global_load_dwordx4 v[220:223], v18, s[6:7] nt
  v_xor_b32 v18, 0x2000, v18
  s_waitcnt vmcnt(4)
  global_load_dwordx4 v[224:227], v18, s[6:7] nt
  v_xor_b32 v18, 0x2400, v18
  s_waitcnt vmcnt(4)
  global_load_dwordx4 v[228:231], v18, s[6:7] nt
  v_xor_b32 v18, 0x2000, v18
  s_waitcnt vmcnt(4)
  global_load_dwordx4 v[232:235], v18, s[6:7] nt
  v_xor_b32 v18, 0x102400, v18
  s_waitcnt vmcnt(4)
  global_load_dwordx4 v[236:239], v18, s[6:7] nt
  v_xor_b32 v18, 0x2000, v18
  s_waitcnt vmcnt(4)
  global_load_dwordx4 v[240:243], v18, s[6:7] nt
  v_xor_b32 v18, 0x2400, v18
  s_waitcnt vmcnt(4)
  global_load_dwordx4 v[244:247], v18, s[6:7] nt
  v_xor_b32 v18, 0x2000, v18
  s_waitcnt vmcnt(4)
  global_load_dwordx4 v[248:251], v18, s[6:7] nt
  v_xor_b32 v18, 0x196400, v18
  s_mov_b32 s35, 8388608
L_lw_1:
  ds_read_b32 v7, v2 offset:3076
  s_waitcnt lgkmcnt(0)
  v_readfirstlane_b32 s34, v7
  s_cmp_eq_u32 s34, 1
  s_cbranch_scc1 L_lwd_2
  s_sub_u32 s35, s35, 1
  s_cbranch_scc0 L_lw_1
L_lwd_2:
  ds_read_b64 v[44:45], v2 offset:3096
  ds_read_b128 v[28:31], v5 offset:2048
  s_waitcnt lgkmcnt(0)
  v_cndmask_b32 v32, 0, v28, s[42:43]
  v_cndmask_b32 v33, 0, v29, s[42:43]
  v_cndmask_b32 v34, 0, v30, s[42:43]
  v_cndmask_b32 v35, 0, v31, s[42:43]
  v_cndmask_b32 v28, v28, 0, s[42:43]
  v_cndmask_b32 v29, v29, 0, s[42:43]
  v_cndmask_b32 v30, v30, 0, s[42:43]
  v_cndmask_b32 v31, v31, 0, s[42:43]
  v_readfirstlane_b32 s62, v44
  v_readfirstlane_b32 s63, v45
  s_xor_b32 s55, s30, 1
  s_lshr_b32 s33, s3, 3
  s_or_b32 s55, s55, s33
  s_mov_b32 s98, 75
  s_mov_b32 s99, -24
  s_mov_b32 s57, 0
  s_cmp_gt_i32 s57, 26
  s_cselect_b64 vcc, -1, 0
  s_cselect_b32 s33, s98, s99
  s_cmp_gt_i32 s57, s33
  v_mfma_f32_16x16x32_bf16 v[64:67], v[124:127], v[28:31], 0
  s_waitcnt vmcnt(4)
  global_load_dwordx4 v[124:127], v18, s[6:7] nt
  v_xor_b32 v18, 0x2000, v18
  v_mfma_f32_16x16x32_bf16 v[64:67], v[128:131], v[32:35], v[64:67]
  v_mfma_f32_16x16x32_bf16 v[68:71], v[132:135], v[28:31], 0
  v_mfma_f32_16x16x32_bf16 v[68:71], v[136:139], v[32:35], v[68:71]
  s_nop 5
  v_add_f32_dpp v80, v65, v64 row_ror:12 row_mask:0xf bank_mask:0xf
  s_nop 1
  v_add_f32_dpp v80, v66, v80 row_ror:8 row_mask:0xf bank_mask:0xf
  s_nop 1
  v_add_f32_dpp v84, v67, v80 row_ror:4 row_mask:0xf bank_mask:0x1
  v_mfma_f32_16x16x32_bf16 v[72:75], v[140:143], v[28:31], 0
  v_mfma_f32_16x16x32_bf16 v[72:75], v[144:147], v[32:35], v[72:75]
  v_add_f32_dpp v81, v70, v69 row_ror:12 row_mask:0xf bank_mask:0xf
  s_nop 1
  v_add_f32_dpp v81, v71, v81 row_ror:8 row_mask:0xf bank_mask:0xf
  s_nop 1
  v_add_f32_dpp v84, v68, v81 row_ror:4 row_mask:0xf bank_mask:0x2
  v_mfma_f32_16x16x32_bf16 v[76:79], v[148:151], v[28:31], 0
  s_waitcnt vmcnt(4)
  global_load_dwordx4 v[128:131], v18, s[6:7] nt
  v_xor_b32 v18, 0x2400, v18
  v_mfma_f32_16x16x32_bf16 v[76:79], v[152:155], v[32:35], v[76:79]
  v_add_f32_dpp v82, v75, v74 row_ror:12 row_mask:0xf bank_mask:0xf
  s_nop 1
  v_add_f32_dpp v82, v72, v82 row_ror:8 row_mask:0xf bank_mask:0xf
  s_nop 1
  v_add_f32_dpp v84, v73, v82 row_ror:4 row_mask:0xf bank_mask:0x4
  v_mfma_f32_16x16x32_bf16 v[64:67], v[156:159], v[28:31], 0
  v_mfma_f32_16x16x32_bf16 v[64:67], v[160:163], v[32:35], v[64:67]
  v_add_f32_dpp v83, v76, v79 row_ror:12 row_mask:0xf bank_mask:0xf
  s_nop 1
  v_add_f32_dpp v83, v77, v83 row_ror:8 row_mask:0xf bank_mask:0xf
  s_nop 1
  v_add_f32_dpp v84, v78, v83 row_ror:4 row_mask:0xf bank_mask:0x8
  v_mfma_f32_16x16x32_bf16 v[68:71], v[164:167], v[28:31], 0
  v_mfma_f32_16x16x32_bf16 v[68:71], v[168:171], v[32:35], v[68:71]
  v_add_f32_dpp v80, v65, v64 row_ror:12 row_mask:0xf bank_mask:0xf
  s_nop 1
  v_add_f32_dpp v80, v66, v80 row_ror:8 row_mask:0xf bank_mask:0xf
  s_nop 1
  v_add_f32_dpp v85, v67, v80 row_ror:4 row_mask:0xf bank_mask:0x1
  v_mfma_f32_16x16x32_bf16 v[72:75], v[172:175], v[28:31], 0
  s_waitcnt vmcnt(4)
  global_load_dwordx4 v[132:135], v18, s[6:7] nt
  v_xor_b32 v18, 0x2000, v18
  v_mfma_f32_16x16x32_bf16 v[72:75], v[176:179], v[32:35], v[72:75]
  v_add_f32_dpp v81, v70, v69 row_ror:12 row_mask:0xf bank_mask:0xf
  s_nop 1
  v_add_f32_dpp v81, v71, v81 row_ror:8 row_mask:0xf bank_mask:0xf
  s_nop 1
  v_add_f32_dpp v85, v68, v81 row_ror:4 row_mask:0xf bank_mask:0x2
  v_mfma_f32_16x16x32_bf16 v[76:79], v[180:183], v[28:31], 0
  v_mfma_f32_16x16x32_bf16 v[76:79], v[184:187], v[32:35], v[76:79]
  v_add_f32_dpp v82, v75, v74 row_ror:12 row_mask:0xf bank_mask:0xf
  s_nop 1
  v_add_f32_dpp v82, v72, v82 row_ror:8 row_mask:0xf bank_mask:0xf
  s_nop 1
  v_add_f32_dpp v85, v73, v82 row_ror:4 row_mask:0xf bank_mask:0x4
  v_mfma_f32_16x16x32_bf16 v[64:67], v[188:191], v[28:31], 0
  v_mfma_f32_16x16x32_bf16 v[64:67], v[192:195], v[32:35], v[64:67]
  v_add_f32_dpp v83, v76, v79 row_ror:12 row_mask:0xf bank_mask:0xf
  s_nop 1
  v_add_f32_dpp v83, v77, v83 row_ror:8 row_mask:0xf bank_mask:0xf
  s_nop 1
  v_add_f32_dpp v85, v78, v83 row_ror:4 row_mask:0xf bank_mask:0x8
  v_mfma_f32_16x16x32_bf16 v[68:71], v[196:199], v[28:31], 0
  s_waitcnt vmcnt(4)
  global_load_dwordx4 v[136:139], v18, s[6:7] nt
  v_xor_b32 v18, 0x102400, v18
  v_mfma_f32_16x16x32_bf16 v[68:71], v[200:203], v[32:35], v[68:71]
  v_add_f32_dpp v80, v65, v64 row_ror:12 row_mask:0xf bank_mask:0xf
  s_nop 1
  v_add_f32_dpp v80, v66, v80 row_ror:8 row_mask:0xf bank_mask:0xf
  s_nop 1
  v_add_f32_dpp v86, v67, v80 row_ror:4 row_mask:0xf bank_mask:0x1
  v_mfma_f32_16x16x32_bf16 v[72:75], v[204:207], v[28:31], 0
  v_mfma_f32_16x16x32_bf16 v[72:75], v[208:211], v[32:35], v[72:75]
  v_add_f32_dpp v81, v70, v69 row_ror:12 row_mask:0xf bank_mask:0xf
  s_nop 1
  v_add_f32_dpp v81, v71, v81 row_ror:8 row_mask:0xf bank_mask:0xf
  s_nop 1
  v_add_f32_dpp v86, v68, v81 row_ror:4 row_mask:0xf bank_mask:0x2
  v_mfma_f32_16x16x32_bf16 v[76:79], v[212:215], v[28:31], 0
  v_mfma_f32_16x16x32_bf16 v[76:79], v[216:219], v[32:35], v[76:79]
  v_add_f32_dpp v82, v75, v74 row_ror:12 row_mask:0xf bank_mask:0xf
  s_nop 1
  v_add_f32_dpp v82, v72, v82 row_ror:8 row_mask:0xf bank_mask:0xf
  s_nop 1
  v_add_f32_dpp v86, v73, v82 row_ror:4 row_mask:0xf bank_mask:0x4
  v_mfma_f32_16x16x32_bf16 v[64:67], v[220:223], v[28:31], 0
  v_mfma_f32_16x16x32_bf16 v[64:67], v[224:227], v[32:35], v[64:67]
  v_add_f32_dpp v83, v76, v79 row_ror:12 row_mask:0xf bank_mask:0xf
  s_nop 1
  v_add_f32_dpp v83, v77, v83 row_ror:8 row_mask:0xf bank_mask:0xf
  s_nop 1
  v_add_f32_dpp v86, v78, v83 row_ror:4 row_mask:0xf bank_mask:0x8
  v_mfma_f32_16x16x32_bf16 v[68:71], v[228:231], v[28:31], 0
  v_mfma_f32_16x16x32_bf16 v[68:71], v[232:235], v[32:35], v[68:71]
  v_add_f32_dpp v80, v65, v64 row_ror:12 row_mask:0xf bank_mask:0xf
  s_nop 1
  v_add_f32_dpp v80, v66, v80 row_ror:8 row_mask:0xf bank_mask:0xf
  s_nop 1
  v_add_f32_dpp v87, v67, v80 row_ror:4 row_mask:0xf bank_mask:0x1
  v_mfma_f32_16x16x32_bf16 v[72:75], v[236:239], v[28:31], 0
  v_mfma_f32_16x16x32_bf16 v[72:75], v[240:243], v[32:35], v[72:75]
  v_add_f32_dpp v81, v70, v69 row_ror:12 row_mask:0xf bank_mask:0xf
  s_nop 1
  v_add_f32_dpp v81, v71, v81 row_ror:8 row_mask:0xf bank_mask:0xf
  s_nop 1
  v_add_f32_dpp v87, v68, v81 row_ror:4 row_mask:0xf bank_mask:0x2
  v_mfma_f32_16x16x32_bf16 v[76:79], v[244:247], v[28:31], 0
  s_waitcnt vmcnt(4)
  global_load_dwordx4 v[140:143], v18, s[6:7] nt
  v_xor_b32 v18, 0x2000, v18
  v_mfma_f32_16x16x32_bf16 v[76:79], v[248:251], v[32:35], v[76:79]
  v_add_f32_dpp v82, v75, v74 row_ror:12 row_mask:0xf bank_mask:0xf
  s_nop 1
  v_add_f32_dpp v82, v72, v82 row_ror:8 row_mask:0xf bank_mask:0xf
  s_nop 1
  v_add_f32_dpp v87, v73, v82 row_ror:4 row_mask:0xf bank_mask:0x4
  s_cbranch_vccnz L_tf_3
  s_cbranch_scc1 L_tm_4
  s_waitcnt vmcnt(3)
L_tm_4:
  s_waitcnt vmcnt(4)
L_tf_3:
  s_cbranch_scc1 L_te_5
  s_waitcnt vmcnt(5)
L_te_5:
  s_waitcnt vmcnt(4)
  global_load_dwordx4 v[144:147], v18, s[6:7] nt
  v_xor_b32 v18, 0x2400, v18
  s_cbranch_vccnz L_tf_6
  s_cbranch_scc1 L_tm_7
  s_waitcnt vmcnt(3)
L_tm_7:
  s_waitcnt vmcnt(4)
L_tf_6:
  s_cbranch_scc1 L_te_8
  s_waitcnt vmcnt(5)
L_te_8:
  global_load_dwordx4 v[148:151], v18, s[6:7] nt
  v_xor_b32 v18, 0x2000, v18
  s_cbranch_vccnz L_tf_9
  s_cbranch_scc1 L_tm_10
  s_waitcnt vmcnt(3)
L_tm_10:
  s_waitcnt vmcnt(4)
L_tf_9:
  s_cbranch_scc1 L_te_11
  s_waitcnt vmcnt(5)
L_te_11:
  global_load_dwordx4 v[152:155], v18, s[6:7] nt
  v_xor_b32 v18, 0x112400, v18
  s_cbranch_vccnz L_tf_12
  s_cbranch_scc1 L_tm_13
  s_waitcnt vmcnt(3)
L_tm_13:
  s_waitcnt vmcnt(4)
L_tf_12:
  s_cbranch_scc1 L_te_14
  s_waitcnt vmcnt(5)
L_te_14:
  global_load_dwordx4 v[156:159], v18, s[6:7] nt
  v_xor_b32 v18, 0x2000, v18
  v_mfma_f32_16x16x32_bf16 v[64:67], v[124:127], v[28:31], 0
  s_cbranch_vccnz L_tf_15
  s_cbranch_scc1 L_tm_16
  s_waitcnt vmcnt(3)
L_tm_16:
  s_waitcnt vmcnt(4)
L_tf_15:
  s_cbranch_scc1 L_te_17
  s_waitcnt vmcnt(5)
L_te_17:
  s_waitcnt vmcnt(7)
  global_load_dwordx4 v[160:163], v18, s[6:7] nt
  v_xor_b32 v18, 0x2400, v18
  v_mfma_f32_16x16x32_bf16 v[64:67], v[128:131], v[32:35], v[64:67]
  v_add_f32_dpp v83, v76, v79 row_ror:12 row_mask:0xf bank_mask:0xf
  s_nop 1
  v_add_f32_dpp v83, v77, v83 row_ror:8 row_mask:0xf bank_mask:0xf
  s_nop 1
  v_add_f32_dpp v87, v78, v83 row_ror:4 row_mask:0xf bank_mask:0x8
  s_cbranch_vccnz L_tf_18
  s_cbranch_scc1 L_tm_19
  s_waitcnt vmcnt(3)
L_tm_19:
  s_waitcnt vmcnt(4)
L_tf_18:
  s_cbranch_scc1 L_te_20
  s_waitcnt vmcnt(5)
L_te_20:
  s_waitcnt vmcnt(7)
  global_load_dwordx4 v[164:167], v18, s[6:7] nt
  v_xor_b32 v18, 0x2000, v18
  v_mfma_f32_16x16x32_bf16 v[68:71], v[132:135], v[28:31], 0
  s_cbranch_vccnz L_tf_21
  s_cbranch_scc1 L_tm_22
  s_waitcnt vmcnt(3)
L_tm_22:
  s_waitcnt vmcnt(4)
L_tf_21:
  s_cbranch_scc1 L_te_23
  s_waitcnt vmcnt(5)
L_te_23:
  s_waitcnt vmcnt(7)
  global_load_dwordx4 v[168:171], v18, s[6:7] nt
  v_xor_b32 v18, 0x102400, v18
  v_mfma_f32_16x16x32_bf16 v[68:71], v[136:139], v[32:35], v[68:71]
  v_add_f32_dpp v80, v65, v64 row_ror:12 row_mask:0xf bank_mask:0xf
  s_nop 1
  v_add_f32_dpp v80, v66, v80 row_ror:8 row_mask:0xf bank_mask:0xf
  s_nop 1
  v_add_f32_dpp v88, v67, v80 row_ror:4 row_mask:0xf bank_mask:0x1
  s_cbranch_vccnz L_tf_24
  s_cbranch_scc1 L_tm_25
  s_waitcnt vmcnt(3)
L_tm_25:
  s_waitcnt vmcnt(4)
L_tf_24:
  s_cbranch_scc1 L_te_26
  s_waitcnt vmcnt(5)
L_te_26:
  s_waitcnt vmcnt(7)
  global_load_dwordx4 v[172:175], v18, s[6:7] nt
  v_xor_b32 v18, 0x2000, v18
  v_mfma_f32_16x16x32_bf16 v[72:75], v[140:143], v[28:31], 0
  s_cbranch_vccnz L_tf_27
  s_cbranch_scc1 L_tm_28
  s_waitcnt vmcnt(3)
L_tm_28:
  s_waitcnt vmcnt(4)
L_tf_27:
  s_cbranch_scc1 L_te_29
  s_waitcnt vmcnt(5)
L_te_29:
  s_waitcnt vmcnt(7)
  global_load_dwordx4 v[176:179], v18, s[6:7] nt
  v_xor_b32 v18, 0x2400, v18
  v_mfma_f32_16x16x32_bf16 v[72:75], v[144:147], v[32:35], v[72:75]
  v_add_f32_dpp v81, v70, v69 row_ror:12 row_mask:0xf bank_mask:0xf
  s_nop 1
  v_add_f32_dpp v81, v71, v81 row_ror:8 row_mask:0xf bank_mask:0xf
  s_nop 1
  v_add_f32_dpp v88, v68, v81 row_ror:4 row_mask:0xf bank_mask:0x2
  s_cbranch_vccnz L_tf_30
  s_cbranch_scc1 L_tm_31
  s_waitcnt vmcnt(3)
L_tm_31:
  s_waitcnt vmcnt(4)
L_tf_30:
  s_cbranch_scc1 L_te_32
  s_waitcnt vmcnt(5)
L_te_32:
  s_waitcnt vmcnt(7)
  global_load_dwordx4 v[180:183], v18, s[6:7] nt
  v_xor_b32 v18, 0x2000, v18
  v_mfma_f32_16x16x32_bf16 v[76:79], v[148:151], v[28:31], 0
  s_cbranch_vccnz L_tf_33
  s_cbranch_scc1 L_tm_34
  s_waitcnt vmcnt(3)
L_tm_34:
  s_waitcnt vmcnt(4)
L_tf_33:
  s_cbranch_scc1 L_te_35
  s_waitcnt vmcnt(5)
L_te_35:
  s_waitcnt vmcnt(7)
  global_load_dwordx4 v[184:187], v18, s[6:7] nt
  v_xor_b32 v18, 0x192400, v18
  v_mfma_f32_16x16x32_bf16 v[76:79], v[152:155], v[32:35], v[76:79]
  v_add_f32_dpp v82, v75, v74 row_ror:12 row_mask:0xf bank_mask:0xf
  s_nop 1
  v_add_f32_dpp v82, v72, v82 row_ror:8 row_mask:0xf bank_mask:0xf
  s_nop 1
  v_add_f32_dpp v88, v73, v82 row_ror:4 row_mask:0xf bank_mask:0x4
  s_cbranch_vccnz L_tf_36
  s_cbranch_scc1 L_tm_37
  s_waitcnt vmcnt(3)
L_tm_37:
  s_waitcnt vmcnt(4)
L_tf_36:
  s_cbranch_scc1 L_te_38
  s_waitcnt vmcnt(5)
L_te_38:
  s_waitcnt vmcnt(7)
  global_load_dwordx4 v[124:127], v18, s[6:7] nt
  v_xor_b32 v18, 0x2000, v18
  v_mfma_f32_16x16x32_bf16 v[64:67], v[156:159], v[28:31], 0
  s_cbranch_vccnz L_tf_39
  s_cbranch_scc1 L_tm_40
  s_waitcnt vmcnt(3)
L_tm_40:
  s_waitcnt vmcnt(4)
L_tf_39:
  s_cbranch_scc1 L_te_41
  s_waitcnt vmcnt(5)
L_te_41:
  s_waitcnt vmcnt(7)
  global_load_dwordx4 v[128:131], v18, s[6:7] nt
  v_xor_b32 v18, 0x2400, v18
  v_mfma_f32_16x16x32_bf16 v[64:67], v[160:163], v[32:35], v[64:67]
  v_add_f32_dpp v83, v76, v79 row_ror:12 row_mask:0xf bank_mask:0xf
  s_nop 1
  v_add_f32_dpp v83, v77, v83 row_ror:8 row_mask:0xf bank_mask:0xf
  s_nop 1
  v_add_f32_dpp v88, v78, v83 row_ror:4 row_mask:0xf bank_mask:0x8
  s_cbranch_vccnz L_tf_42
  s_cbranch_scc1 L_tm_43
  s_waitcnt vmcnt(3)
L_tm_43:
  s_waitcnt vmcnt(4)
L_tf_42:
  s_cbranch_scc1 L_te_44
  s_waitcnt vmcnt(5)
L_te_44:
  s_waitcnt vmcnt(7)
  global_load_dwordx4 v[132:135], v18, s[6:7] nt
  v_xor_b32 v18, 0x2000, v18
  v_mfma_f32_16x16x32_bf16 v[68:71], v[164:167], v[28:31], 0
  s_cbranch_vccnz L_tf_45
  s_cbranch_scc1 L_tm_46
  s_waitcnt vmcnt(3)
L_tm_46:
  s_waitcnt vmcnt(4)
L_tf_45:
  s_cbranch_scc1 L_te_47
  s_waitcnt vmcnt(5)
L_te_47:
  s_waitcnt vmcnt(7)
  global_load_dwordx4 v[136:139], v18, s[6:7] nt
  v_xor_b32 v18, 0x102400, v18
  v_mfma_f32_16x16x32_bf16 v[68:71], v[168:171], v[32:35], v[68:71]
  v_add_f32_dpp v80, v65, v64 row_ror:12 row_mask:0xf bank_mask:0xf
  s_nop 1
  v_add_f32_dpp v80, v66, v80 row_ror:8 row_mask:0xf bank_mask:0xf
  s_nop 1
  v_add_f32_dpp v89, v67, v80 row_ror:4 row_mask:0xf bank_mask:0x1
  s_cbranch_vccnz L_tf_48
  s_cbranch_scc1 L_tm_49
  s_waitcnt vmcnt(3)
L_tm_49:
  s_waitcnt vmcnt(4)
L_tf_48:
  s_cbranch_scc1 L_te_50
  s_waitcnt vmcnt(5)
L_te_50:
  s_waitcnt vmcnt(7)
  global_load_dwordx4 v[140:143], v18, s[6:7] nt
  v_xor_b32 v18, 0x2000, v18
  v_mfma_f32_16x16x32_bf16 v[72:75], v[172:175], v[28:31], 0
  s_memrealtime s[58:59]
  s_cbranch_vccnz L_tf_51
  s_cbranch_scc1 L_tm_52
  s_waitcnt vmcnt(3)
L_tm_52:
  s_waitcnt vmcnt(4)
L_tf_51:
  s_cbranch_scc1 L_te_53
  s_waitcnt vmcnt(5)
L_te_53:
  s_waitcnt vmcnt(7)
  global_load_dwordx4 v[144:147], v18, s[6:7] nt
  v_xor_b32 v18, 0x2400, v18
  v_mfma_f32_16x16x32_bf16 v[72:75], v[176:179], v[32:35], v[72:75]
  v_add_f32_dpp v81, v70, v69 row_ror:12 row_mask:0xf bank_mask:0xf
  s_nop 1
  v_add_f32_dpp v81, v71, v81 row_ror:8 row_mask:0xf bank_mask:0xf
  s_nop 1
  v_add_f32_dpp v89, v68, v81 row_ror:4 row_mask:0xf bank_mask:0x2
  s_cbranch_vccnz L_tf_54
  s_cbranch_scc1 L_tm_55
  s_waitcnt vmcnt(3)
L_tm_55:
  s_waitcnt vmcnt(4)
L_tf_54:
  s_cbranch_scc1 L_te_56
  s_waitcnt vmcnt(5)
L_te_56:
  s_waitcnt vmcnt(7)
  global_load_dwordx4 v[148:151], v18, s[6:7] nt
  v_xor_b32 v18, 0x2000, v18
  v_mfma_f32_16x16x32_bf16 v[76:79], v[180:183], v[28:31], 0
  s_waitcnt lgkmcnt(0)
  s_cmp_lg_u32 s55, 0
  s_cbranch_scc1 L_opt_57
  s_add_u32 s58, s58, s62
  s_lshl_b32 s33, s3, 8
  s_add_u32 s33, s33, 147456
  v_mov_b32 v7, s33
  v_mov_b32 v8, s58
  s_mov_b64 exec, 1
  global_store_dword v7, v8, s[28:29] sc1
  s_mov_b64 exec, -1
  s_nop 1
L_opt_57:
  s_cmp_gt_i32 s57, 26
  s_cselect_b64 vcc, -1, 0
  s_cselect_b32 s33, s98, s99
  s_cmp_gt_i32 s57, s33
  s_cbranch_vccnz L_tf_58
  s_cbranch_scc1 L_tm_59
  s_waitcnt vmcnt(3)
L_tm_59:
  s_waitcnt vmcnt(4)
L_tf_58:
  s_cbranch_scc1 L_te_60
  s_waitcnt vmcnt(5)
L_te_60:
  s_waitcnt vmcnt(7)
  global_load_dwordx4 v[152:155], v18, s[6:7] nt
  v_xor_b32 v18, 0x112400, v18
  v_mfma_f32_16x16x32_bf16 v[76:79], v[184:187], v[32:35], v[76:79]
  v_add_f32_dpp v82, v75, v74 row_ror:12 row_mask:0xf bank_mask:0xf
  s_nop 1
  v_add_f32_dpp v82, v72, v82 row_ror:8 row_mask:0xf bank_mask:0xf
  s_nop 1
  v_add_f32_dpp v89, v73, v82 row_ror:4 row_mask:0xf bank_mask:0x4
  s_cbranch_vccnz L_tf_61
  s_cbranch_scc1 L_tm_62
  s_waitcnt vmcnt(3)
L_tm_62:
  s_waitcnt vmcnt(4)
L_tf_61:
  s_cbranch_scc1 L_te_63
  s_waitcnt vmcnt(5)
L_te_63:
  s_waitcnt vmcnt(7)
  global_load_dwordx4 v[156:159], v18, s[6:7] nt
  v_xor_b32 v18, 0x2000, v18
  v_mfma_f32_16x16x32_bf16 v[64:67], v[124:127], v[28:31], 0
  s_cbranch_vccnz L_tf_64
  s_cbranch_scc1 L_tm_65
  s_waitcnt vmcnt(3)
L_tm_65:
  s_waitcnt vmcnt(4)
L_tf_64:
  s_cbranch_scc1 L_te_66
  s_waitcnt vmcnt(5)
L_te_66:
  s_waitcnt vmcnt(7)
  global_load_dwordx4 v[160:163], v18, s[6:7] nt
  v_xor_b32 v18, 0x2400, v18
  v_mfma_f32_16x16x32_bf16 v[64:67], v[128:131], v[32:35], v[64:67]
  v_add_f32_dpp v83, v76, v79 row_ror:12 row_mask:0xf bank_mask:0xf
  s_nop 1
  v_add_f32_dpp v83, v77, v83 row_ror:8 row_mask:0xf bank_mask:0xf
  s_nop 1
  v_add_f32_dpp v89, v78, v83 row_ror:4 row_mask:0xf bank_mask:0x8
  s_cbranch_vccnz L_tf_67
  s_cbranch_scc1 L_tm_68
  s_waitcnt vmcnt(3)
L_tm_68:
  s_waitcnt vmcnt(4)
L_tf_67:
  s_cbranch_scc1 L_te_69
  s_waitcnt vmcnt(5)
L_te_69:
  s_waitcnt vmcnt(7)
  global_load_dwordx4 v[164:167], v18, s[6:7] nt
  v_xor_b32 v18, 0x2000, v18
  v_mfma_f32_16x16x32_bf16 v[68:71], v[132:135], v[28:31], 0
  s_cbranch_vccnz L_tf_70
  s_cbranch_scc1 L_tm_71
  s_waitcnt vmcnt(3)
L_tm_71:
  s_waitcnt vmcnt(4)
L_tf_70:
  s_cbranch_scc1 L_te_72
  s_waitcnt vmcnt(5)
L_te_72:
  s_waitcnt vmcnt(7)
  global_load_dwordx4 v[168:171], v18, s[6:7] nt
  v_xor_b32 v18, 0x102400, v18
  v_mfma_f32_16x16x32_bf16 v[68:71], v[136:139], v[32:35], v[68:71]
  v_add_f32_dpp v80, v65, v64 row_ror:12 row_mask:0xf bank_mask:0xf
  s_nop 1
  v_add_f32_dpp v80, v66, v80 row_ror:8 row_mask:0xf bank_mask:0xf
  s_nop 1
  v_add_f32_dpp v90, v67, v80 row_ror:4 row_mask:0xf bank_mask:0x1
  s_cbranch_vccnz L_tf_73
  s_cbranch_scc1 L_tm_74
  s_waitcnt vmcnt(3)
L_tm_74:
  s_waitcnt vmcnt(4)
L_tf_73:
  s_cbranch_scc1 L_te_75
  s_waitcnt vmcnt(5)
L_te_75:
  s_waitcnt vmcnt(7)
  global_load_dwordx4 v[172:175], v18, s[6:7] nt
  v_xor_b32 v18, 0x2000, v18
  v_mfma_f32_16x16x32_bf16 v[72:75], v[140:143], v[28:31], 0
  s_cbranch_vccnz L_tf_76
  s_cbranch_scc1 L_tm_77
  s_waitcnt vmcnt(3)
L_tm_77:
  s_waitcnt vmcnt(4)
L_tf_76:
  s_cbranch_scc1 L_te_78
  s_waitcnt vmcnt(5)
L_te_78:
  s_waitcnt vmcnt(7)
  global_load_dwordx4 v[176:179], v18, s[6:7] nt
  v_xor_b32 v18, 0x2400, v18
  v_mfma_f32_16x16x32_bf16 v[72:75], v[144:147], v[32:35], v[72:75]
  v_add_f32_dpp v81, v70, v69 row_ror:12 row_mask:0xf bank_mask:0xf
  s_nop 1
  v_add_f32_dpp v81, v71, v81 row_ror:8 row_mask:0xf bank_mask:0xf
  s_nop 1
  v_add_f32_dpp v90, v68, v81 row_ror:4 row_mask:0xf bank_mask:0x2
  s_cbranch_vccnz L_tf_79
  s_cbranch_scc1 L_tm_80
  s_waitcnt vmcnt(3)
L_tm_80:
  s_waitcnt vmcnt(4)
L_tf_79:
  s_cbranch_scc1 L_te_81
  s_waitcnt vmcnt(5)
L_te_81:
  s_waitcnt vmcnt(7)
  global_load_dwordx4 v[180:183], v18, s[6:7] nt
  v_xor_b32 v18, 0x2000, v18
  v_mfma_f32_16x16x32_bf16 v[76:79], v[148:151], v[28:31], 0
  s_cbranch_vccnz L_tf_82
  s_cbranch_scc1 L_tm_83
  s_waitcnt vmcnt(3)
L_tm_83:
  s_waitcnt vmcnt(4)
L_tf_82:
  s_cbranch_scc1 L_te_84
  s_waitcnt vmcnt(5)
L_te_84:
  s_waitcnt vmcnt(7)
  global_load_dwordx4 v[184:187], v18, s[6:7] nt
  v_xor_b32 v18, 0x596400, v18
  v_mfma_f32_16x16x32_bf16 v[76:79], v[152:155], v[32:35], v[76:79]
  v_add_f32_dpp v82, v75, v74 row_ror:12 row_mask:0xf bank_mask:0xf
  s_nop 1
  v_add_f32_dpp v82, v72, v82 row_ror:8 row_mask:0xf bank_mask:0xf
  s_nop 1
  v_add_f32_dpp v90, v73, v82 row_ror:4 row_mask:0xf bank_mask:0x4
  s_cbranch_vccnz L_tf_85
  s_cbranch_scc1 L_tm_86
  s_waitcnt vmcnt(3)
L_tm_86:
  s_waitcnt vmcnt(4)
L_tf_85:
  s_cbranch_scc1 L_te_87
  s_waitcnt vmcnt(5)
L_te_87:
  s_waitcnt vmcnt(7)
  global_load_dwordx4 v[124:127], v18, s[6:7] nt
  v_xor_b32 v18, 0x2000, v18
  v_mfma_f32_16x16x32_bf16 v[64:67], v[156:159], v[28:31], 0
  s_cbranch_vccnz L_tf_88
  s_cbranch_scc1 L_tm_89
  s_waitcnt vmcnt(3)
L_tm_89:
  s_waitcnt vmcnt(4)
L_tf_88:
  s_cbranch_scc1 L_te_90
  s_waitcnt vmcnt(5)
L_te_90:
  s_waitcnt vmcnt(7)
  global_load_dwordx4 v[128:131], v18, s[6:7] nt
  v_xor_b32 v18, 0x2400, v18
  v_mfma_f32_16x16x32_bf16 v[64:67], v[160:163], v[32:35], v[64:67]
  v_add_f32_dpp v83, v76, v79 row_ror:12 row_mask:0xf bank_mask:0xf
  s_nop 1
  v_add_f32_dpp v83, v77, v83 row_ror:8 row_mask:0xf bank_mask:0xf
  s_nop 1
  v_add_f32_dpp v90, v78, v83 row_ror:4 row_mask:0xf bank_mask:0x8
  s_cbranch_vccnz L_tf_91
  s_cbranch_scc1 L_tm_92
  s_waitcnt vmcnt(3)
L_tm_92:
  s_waitcnt vmcnt(4)
L_tf_91:
  s_cbranch_scc1 L_te_93
  s_waitcnt vmcnt(5)
L_te_93:
  s_waitcnt vmcnt(7)
  global_load_dwordx4 v[132:135], v18, s[6:7] nt
  v_xor_b32 v18, 0x2000, v18
  v_mfma_f32_16x16x32_bf16 v[68:71], v[164:167], v[28:31], 0
  s_cbranch_vccnz L_tf_94
  s_cbranch_scc1 L_tm_95
  s_waitcnt vmcnt(3)
L_tm_95:
  s_waitcnt vmcnt(4)
L_tf_94:
  s_cbranch_scc1 L_te_96
  s_waitcnt vmcnt(5)
L_te_96:
  s_waitcnt vmcnt(7)
  global_load_dwordx4 v[136:139], v18, s[6:7] nt
  v_xor_b32 v18, 0x102400, v18
  v_mfma_f32_16x16x32_bf16 v[68:71], v[168:171], v[32:35], v[68:71]
  v_add_f32_dpp v80, v65, v64 row_ror:12 row_mask:0xf bank_mask:0xf
  s_nop 1
  v_add_f32_dpp v80, v66, v80 row_ror:8 row_mask:0xf bank_mask:0xf
  s_nop 1
  v_add_f32_dpp v91, v67, v80 row_ror:4 row_mask:0xf bank_mask:0x1
  s_cbranch_vccnz L_tf_97
  s_cbranch_scc1 L_tm_98
  s_waitcnt vmcnt(3)
L_tm_98:
  s_waitcnt vmcnt(4)
L_tf_97:
  s_cbranch_scc1 L_te_99
  s_waitcnt vmcnt(5)
L_te_99:
  s_waitcnt vmcnt(7)
  global_load_dwordx4 v[140:143], v18, s[6:7] nt
  v_xor_b32 v18, 0x2000, v18
  v_mfma_f32_16x16x32_bf16 v[72:75], v[172:175], v[28:31], 0
  v_mov_b32 v8, 1
  s_mov_b64 exec, 1
  ds_add_u32 v2, v8 offset:3120
  s_mov_b64 exec, -1
  s_cbranch_vccnz L_tf_100
  s_cbranch_scc1 L_tm_101
  s_waitcnt vmcnt(3)
L_tm_101:
  s_waitcnt vmcnt(4)
L_tf_100:
  s_cbranch_scc1 L_te_102
  s_waitcnt vmcnt(5)
L_te_102:
  s_waitcnt vmcnt(7)
  global_load_dwordx4 v[144:147], v18, s[6:7] nt
  v_xor_b32 v18, 0x2400, v18
  v_mfma_f32_16x16x32_bf16 v[72:75], v[176:179], v[32:35], v[72:75]
  v_add_f32_dpp v81, v70, v69 row_ror:12 row_mask:0xf bank_mask:0xf
  s_nop 1
  v_add_f32_dpp v81, v71, v81 row_ror:8 row_mask:0xf bank_mask:0xf
  s_nop 1
  v_add_f32_dpp v91, v68, v81 row_ror:4 row_mask:0xf bank_mask:0x2
  s_cbranch_vccnz L_tf_103
  s_cbranch_scc1 L_tm_104
  s_waitcnt vmcnt(3)
L_tm_104:
  s_waitcnt vmcnt(4)
L_tf_103:
  s_cbranch_scc1 L_te_105
  s_waitcnt vmcnt(5)
L_te_105:
  s_waitcnt vmcnt(7)
  global_load_dwordx4 v[148:151], v18, s[6:7] nt
  v_xor_b32 v18, 0x2000, v18
  v_mfma_f32_16x16x32_bf16 v[76:79], v[180:183], v[28:31], 0
  s_cbranch_vccnz L_tf_106
  s_cbranch_scc1 L_tm_107
  s_waitcnt vmcnt(3)
L_tm_107:
  s_waitcnt vmcnt(4)
L_tf_106:
  s_cbranch_scc1 L_te_108
  s_waitcnt vmcnt(5)
L_te_108:
  s_waitcnt vmcnt(7)
  global_load_dwordx4 v[152:155], v18, s[6:7] nt
  v_xor_b32 v18, 0x112400, v18
  v_mfma_f32_16x16x32_bf16 v[76:79], v[184:187], v[32:35], v[76:79]
  v_add_f32_dpp v82, v75, v74 row_ror:12 row_mask:0xf bank_mask:0xf
  s_nop 1
  v_add_f32_dpp v82, v72, v82 row_ror:8 row_mask:0xf bank_mask:0xf
  s_nop 1
  v_add_f32_dpp v91, v73, v82 row_ror:4 row_mask:0xf bank_mask:0x4
  s_cbranch_vccnz L_tf_109
  s_cbranch_scc1 L_tm_110
  s_waitcnt vmcnt(3)
L_tm_110:
  s_waitcnt vmcnt(4)
L_tf_109:
  s_cbranch_scc1 L_te_111
  s_waitcnt vmcnt(5)
L_te_111:
  s_waitcnt vmcnt(7)
  global_load_dwordx4 v[156:159], v18, s[6:7] nt
  v_xor_b32 v18, 0x2000, v18
  v_mfma_f32_16x16x32_bf16 v[64:67], v[124:127], v[28:31], 0
  s_cbranch_vccnz L_tf_112
  s_cbranch_scc1 L_tm_113
  s_waitcnt vmcnt(3)
L_tm_113:
  s_waitcnt vmcnt(4)
L_tf_112:
  s_cbranch_scc1 L_te_114
  s_waitcnt vmcnt(5)
L_te_114:
  s_waitcnt vmcnt(7)
  global_load_dwordx4 v[160:163], v18, s[6:7] nt
  v_xor_b32 v18, 0x2400, v18
  v_mfma_f32_16x16x32_bf16 v[64:67], v[128:131], v[32:35], v[64:67]
  v_add_f32_dpp v83, v76, v79 row_ror:12 row_mask:0xf bank_mask:0xf
  s_nop 1
  v_add_f32_dpp v83, v77, v83 row_ror:8 row_mask:0xf bank_mask:0xf
  s_nop 1
  v_add_f32_dpp v91, v78, v83 row_ror:4 row_mask:0xf bank_mask:0x8
  global_load_dwordx4 v[164:167], v18, s[6:7] nt
  v_xor_b32 v18, 0x2000, v18
  v_max3_f32 v7, v84, v85, v86
  v_max3_f32 v8, v87, v88, v89
  v_max3_f32 v7, v7, v90, v91
  v_max_f32 v7, v7, v8
  s_nop 1
  v_max_f32_dpp v7, v7, v7 row_ror:2 row_mask:0xf bank_mask:0xf
  s_nop 1
  v_max_f32_dpp v7, v7, v7 row_ror:4 row_mask:0xf bank_mask:0xf
  s_nop 1
  v_max_f32_dpp v7, v7, v7 row_ror:8 row_mask:0xf bank_mask:0xf
  v_mov_b32 v8, v7
  s_nop 1
  v_permlane16_swap_b32 v7, v8
  v_max_f32 v7, v7, v8
  v_mov_b32 v8, v7
  s_nop 1
  v_permlane32_swap_b32 v7, v8
  v_max_f32 v7, v7, v8
  v_mul_f32 v9, s40, v7
  v_fma_f32 v84, v84, s40, -v9
  v_fma_f32 v85, v85, s40, -v9
  v_fma_f32 v86, v86, s40, -v9
  v_fma_f32 v87, v87, s40, -v9
  v_fma_f32 v88, v88, s40, -v9
  v_fma_f32 v89, v89, s40, -v9
  v_fma_f32 v90, v90, s40, -v9
  v_fma_f32 v91, v91, s40, -v9
  v_exp_f32 v84, v84
  v_exp_f32 v85, v85
  v_exp_f32 v86, v86
  v_exp_f32 v87, v87
  v_exp_f32 v88, v88
  v_exp_f32 v89, v89
  v_exp_f32 v90, v90
  v_exp_f32 v91, v91
  v_cvt_pk_bf16_f32 v48, v84, v85
  v_cvt_pk_bf16_f32 v49, v86, v87
  v_cvt_pk_bf16_f32 v50, v88, v89
  v_cvt_pk_bf16_f32 v51, v90, v91
  v_add_f32 v10, v85, v84
  v_add_f32 v10, v86, v10
  v_add_f32 v10, v87, v10
  v_add_f32 v10, v88, v10
  v_add_f32 v10, v89, v10
  v_add_f32 v10, v90, v10
  v_add_f32 v10, v91, v10
  v_mov_b32_dpp v17, v9 quad_perm:[0,0,0,0] row_mask:0x3 bank_mask:0xf
  s_nop 1
  v_mov_b32_dpp v17, v9 quad_perm:[1,1,1,1] row_mask:0xc bank_mask:0xf
  s_cmp_gt_i32 s57, 26
  s_cselect_b64 vcc, -1, 0
  s_cselect_b32 s33, s98, s99
  s_cmp_gt_i32 s57, s33
  s_waitcnt vmcnt(8)
  v_mfma_f32_16x16x32_bf16 v[68:71], v[132:135], v[28:31], 0
  s_cbranch_vccnz L_tf_115
  s_cbranch_scc1 L_tm_116
  s_waitcnt vmcnt(3)
L_tm_116:
  s_waitcnt vmcnt(4)
L_tf_115:
  s_cbranch_scc1 L_te_117
  s_waitcnt vmcnt(5)
L_te_117:
  s_waitcnt vmcnt(7)
  global_load_dwordx4 v[168:171], v18, s[6:7] nt
  v_xor_b32 v18, 0x102400, v18
  v_mfma_f32_16x16x32_bf16 v[68:71], v[136:139], v[32:35], v[68:71]
  v_add_f32_dpp v80, v65, v64 row_ror:12 row_mask:0xf bank_mask:0xf
  s_nop 1
  v_add_f32_dpp v80, v66, v80 row_ror:8 row_mask:0xf bank_mask:0xf
  s_nop 1
  v_add_f32_dpp v84, v67, v80 row_ror:4 row_mask:0xf bank_mask:0x1
  s_cbranch_vccnz L_tf_118
  s_cbranch_scc1 L_tm_119
  s_waitcnt vmcnt(3)
L_tm_119:
  s_waitcnt vmcnt(4)
L_tf_118:
  s_cbranch_scc1 L_te_120
  s_waitcnt vmcnt(5)
L_te_120:
  s_waitcnt vmcnt(7)
  global_load_dwordx4 v[172:175], v18, s[6:7] nt
  v_xor_b32 v18, 0x2000, v18
  v_mfma_f32_16x16x32_bf16 v[72:75], v[140:143], v[28:31], 0
  s_memrealtime s[58:59]
  ds_read_b64 v[252:253], v2 offset:3112
  s_cbranch_vccnz L_tf_121
  s_cbranch_scc1 L_tm_122
  s_waitcnt vmcnt(3)
L_tm_122:
  s_waitcnt vmcnt(4)
L_tf_121:
  s_cbranch_scc1 L_te_123
  s_waitcnt vmcnt(5)
L_te_123:
  s_waitcnt vmcnt(7)
  global_load_dwordx4 v[176:179], v18, s[6:7] nt
  v_xor_b32 v18, 0x2400, v18
  v_mfma_f32_16x16x32_bf16 v[72:75], v[144:147], v[32:35], v[72:75]
  v_add_f32_dpp v81, v70, v69 row_ror:12 row_mask:0xf bank_mask:0xf
  s_nop 1
  v_add_f32_dpp v81, v71, v81 row_ror:8 row_mask:0xf bank_mask:0xf
  s_nop 1
  v_add_f32_dpp v84, v68, v81 row_ror:4 row_mask:0xf bank_mask:0x2
  s_cbranch_vccnz L_tf_124
  s_cbranch_scc1 L_tm_125
  s_waitcnt vmcnt(3)
L_tm_125:
  s_waitcnt vmcnt(4)
L_tf_124:
  s_cbranch_scc1 L_te_126
  s_waitcnt vmcnt(5)
L_te_126:
  s_waitcnt vmcnt(7)
  global_load_dwordx4 v[180:183], v18, s[6:7] nt
  v_xor_b32 v18, 0x2000, v18
  v_mfma_f32_16x16x32_bf16 v[76:79], v[148:151], v[28:31], 0
  s_waitcnt lgkmcnt(0)
  v_readfirstlane_b32 s54, v252
  v_readfirstlane_b32 s59, v253
  s_sub_u32 s57, s58, s54
  s_mul_i32 s33, s59, 8
  s_lshr_b32 s33, s33, 4
  s_cselect_b32 s57, s57, 0
  s_sub_u32 s57, s57, s33
  s_cmp_gt_i32 s57, 26
  s_cselect_b64 vcc, -1, 0
  s_cselect_b32 s33, s98, s99
  s_cmp_gt_i32 s57, s33
  s_cbranch_vccnz L_tf_127
  s_cbranch_scc1 L_tm_128
  s_waitcnt vmcnt(3)
L_tm_128:
  s_waitcnt vmcnt(4)
L_tf_127:
  s_cbranch_scc1 L_te_129
  s_waitcnt vmcnt(5)
L_te_129:
  s_waitcnt vmcnt(7)
  global_load_dwordx4 v[184:187], v18, s[6:7] nt
  v_xor_b32 v18, 0x192400, v18
  v_mfma_f32_16x16x32_bf16 v[76:79], v[152:155], v[32:35], v[76:79]
  v_add_f32_dpp v82, v75, v74 row_ror:12 row_mask:0xf bank_mask:0xf
  s_nop 1
  v_add_f32_dpp v82, v72, v82 row_ror:8 row_mask:0xf bank_mask:0xf
  s_nop 1
  v_add_f32_dpp v84, v73, v82 row_ror:4 row_mask:0xf bank_mask:0x4
  s_cbranch_vccnz L_tf_130
  s_cbranch_scc1 L_tm_131
  s_waitcnt vmcnt(3)
L_tm_131:
  s_waitcnt vmcnt(4)
L_tf_130:
  s_cbranch_scc1 L_te_132
  s_waitcnt vmcnt(5)
L_te_132:
  s_waitcnt vmcnt(7)
  global_load_dwordx4 v[124:127], v18, s[6:7] nt
  v_xor_b32 v18, 0x2000, v18
  v_mfma_f32_16x16x32_bf16 v[64:67], v[156:159], v[28:31], 0
  s_cbranch_vccnz L_tf_133
  s_cbranch_scc1 L_tm_134
  s_waitcnt vmcnt(3)
L_tm_134:
  s_waitcnt vmcnt(4)
L_tf_133:
  s_cbranch_scc1 L_te_135
  s_waitcnt vmcnt(5)
L_te_135:
  s_waitcnt vmcnt(7)
  global_load_dwordx4 v[128:131], v18, s[6:7] nt
  v_xor_b32 v18, 0x2400, v18
  v_mfma_f32_16x16x32_bf16 v[64:67], v[160:163], v[32:35], v[64:67]
  v_add_f32_dpp v83, v76, v79 row_ror:12 row_mask:0xf bank_mask:0xf
  s_nop 1
  v_add_f32_dpp v83, v77, v83 row_ror:8 row_mask:0xf bank_mask:0xf
  s_nop 1
  v_add_f32_dpp v84, v78, v83 row_ror:4 row_mask:0xf bank_mask:0x8
  s_cbranch_vccnz L_tf_136
  s_cbranch_scc1 L_tm_137
  s_waitcnt vmcnt(3)
L_tm_137:
  s_waitcnt vmcnt(4)
L_tf_136:
  s_cbranch_scc1 L_te_138
  s_waitcnt vmcnt(5)
L_te_138:
  s_waitcnt vmcnt(7)
  global_load_dwordx4 v[132:135], v18, s[6:7] nt
  v_xor_b32 v18, 0x2000, v18
  v_mfma_f32_16x16x32_bf16 v[68:71], v[164:167], v[28:31], 0
  s_cbranch_vccnz L_tf_139
  s_cbranch_scc1 L_tm_140
  s_waitcnt vmcnt(3)
L_tm_140:
  s_waitcnt vmcnt(4)
L_tf_139:
  s_cbranch_scc1 L_te_141
  s_waitcnt vmcnt(5)
L_te_141:
  s_waitcnt vmcnt(7)
  global_load_dwordx4 v[136:139], v18, s[6:7] nt
  v_xor_b32 v18, 0x102400, v18
  v_mfma_f32_16x16x32_bf16 v[68:71], v[168:171], v[32:35], v[68:71]
  v_add_f32_dpp v80, v65, v64 row_ror:12 row_mask:0xf bank_mask:0xf
  s_nop 1
  v_add_f32_dpp v80, v66, v80 row_ror:8 row_mask:0xf bank_mask:0xf
  s_nop 1
  v_add_f32_dpp v85, v67, v80 row_ror:4 row_mask:0xf bank_mask:0x1
  s_cbranch_vccnz L_tf_142
  s_cbranch_scc1 L_tm_143
  s_waitcnt vmcnt(3)
L_tm_143:
  s_waitcnt vmcnt(4)
L_tf_142:
  s_cbranch_scc1 L_te_144
  s_waitcnt vmcnt(5)
L_te_144:
  s_waitcnt vmcnt(7)
  global_load_dwordx4 v[140:143], v18, s[6:7] nt
  v_xor_b32 v18, 0x2000, v18
  v_mfma_f32_16x16x32_bf16 v[72:75], v[172:175], v[28:31], 0
  s_memrealtime s[58:59]
  ds_read_b64 v[252:253], v2 offset:3112
  s_cbranch_vccnz L_tf_145
  s_cbranch_scc1 L_tm_146
  s_waitcnt vmcnt(3)
L_tm_146:
  s_waitcnt vmcnt(4)
L_tf_145:
  s_cbranch_scc1 L_te_147
  s_waitcnt vmcnt(5)
L_te_147:
  s_waitcnt vmcnt(7)
  global_load_dwordx4 v[144:147], v18, s[6:7] nt
  v_xor_b32 v18, 0x2400, v18
  v_mfma_f32_16x16x32_bf16 v[72:75], v[176:179], v[32:35], v[72:75]
  v_add_f32_dpp v81, v70, v69 row_ror:12 row_mask:0xf bank_mask:0xf
  s_nop 1
  v_add_f32_dpp v81, v71, v81 row_ror:8 row_mask:0xf bank_mask:0xf
  s_nop 1
  v_add_f32_dpp v85, v68, v81 row_ror:4 row_mask:0xf bank_mask:0x2
  s_cbranch_vccnz L_tf_148
  s_cbranch_scc1 L_tm_149
  s_waitcnt vmcnt(3)
L_tm_149:
  s_waitcnt vmcnt(4)
L_tf_148:
  s_cbranch_scc1 L_te_150
  s_waitcnt vmcnt(5)
L_te_150:
  s_waitcnt vmcnt(7)
  global_load_dwordx4 v[148:151], v18, s[6:7] nt
  v_xor_b32 v18, 0x2000, v18
  v_mfma_f32_16x16x32_bf16 v[76:79], v[180:183], v[28:31], 0
  s_waitcnt lgkmcnt(0)
  v_readfirstlane_b32 s54, v252
  v_readfirstlane_b32 s59, v253
  s_sub_u32 s57, s58, s54
  s_mul_i32 s33, s59, 9
  s_lshr_b32 s33, s33, 4
  s_cselect_b32 s57, s57, 0
  s_sub_u32 s57, s57, s33
  s_cmp_lg_u32 s55, 0
  s_cbranch_scc1 L_opt_151
  s_add_u32 s58, s58, s62
  s_lshl_b32 s33, s3, 8
  s_add_u32 s33, s33, 151808
  v_mov_b32 v7, s33
  v_mov_b32 v8, s58
  s_mov_b64 exec, 1
  global_store_dword v7, v8, s[28:29] sc1
  s_mov_b64 exec, -1
  s_nop 1
L_opt_151:
  s_cmp_gt_i32 s57, 26
  s_cselect_b64 vcc, -1, 0
  s_cselect_b32 s33, s98, s99
  s_cmp_gt_i32 s57, s33
  s_cbranch_vccnz L_tf_152
  s_cbranch_scc1 L_tm_153
  s_waitcnt vmcnt(3)
L_tm_153:
  s_waitcnt vmcnt(4)
L_tf_152:
  s_cbranch_scc1 L_te_154
  s_waitcnt vmcnt(5)
L_te_154:
  s_waitcnt vmcnt(7)
  global_load_dwordx4 v[152:155], v18, s[6:7] nt
  v_xor_b32 v18, 0x112400, v18
  v_mfma_f32_16x16x32_bf16 v[76:79], v[184:187], v[32:35], v[76:79]
  v_add_f32_dpp v82, v75, v74 row_ror:12 row_mask:0xf bank_mask:0xf
  s_nop 1
  v_add_f32_dpp v82, v72, v82 row_ror:8 row_mask:0xf bank_mask:0xf
  s_nop 1
  v_add_f32_dpp v85, v73, v82 row_ror:4 row_mask:0xf bank_mask:0x4
  s_cbranch_vccnz L_tf_155
  s_cbranch_scc1 L_tm_156
  s_waitcnt vmcnt(3)
L_tm_156:
  s_waitcnt vmcnt(4)
L_tf_155:
  s_cbranch_scc1 L_te_157
  s_waitcnt vmcnt(5)
L_te_157:
  s_waitcnt vmcnt(7)
  global_load_dwordx4 v[156:159], v18, s[6:7] nt
  v_xor_b32 v18, 0x2000, v18
  v_mfma_f32_16x16x32_bf16 v[64:67], v[124:127], v[28:31], 0
  s_cbranch_vccnz L_tf_158
  s_cbranch_scc1 L_tm_159
  s_waitcnt vmcnt(3)
L_tm_159:
  s_waitcnt vmcnt(4)
L_tf_158:
  s_cbranch_scc1 L_te_160
  s_waitcnt vmcnt(5)
L_te_160:
  s_waitcnt vmcnt(7)
  global_load_dwordx4 v[160:163], v18, s[6:7] nt
  v_xor_b32 v18, 0x2400, v18
  v_mfma_f32_16x16x32_bf16 v[64:67], v[128:131], v[32:35], v[64:67]
  v_add_f32_dpp v83, v76, v79 row_ror:12 row_mask:0xf bank_mask:0xf
  s_nop 1
  v_add_f32_dpp v83, v77, v83 row_ror:8 row_mask:0xf bank_mask:0xf
  s_nop 1
  v_add_f32_dpp v85, v78, v83 row_ror:4 row_mask:0xf bank_mask:0x8
  s_cbranch_vccnz L_tf_161
  s_cbranch_scc1 L_tm_162
  s_waitcnt vmcnt(3)
L_tm_162:
  s_waitcnt vmcnt(4)
L_tf_161:
  s_cbranch_scc1 L_te_163
  s_waitcnt vmcnt(5)
L_te_163:
  s_waitcnt vmcnt(7)
  global_load_dwordx4 v[164:167], v18, s[6:7] nt
  v_xor_b32 v18, 0x2000, v18
  v_mfma_f32_16x16x32_bf16 v[68:71], v[132:135], v[28:31], 0
  s_cbranch_vccnz L_tf_164
  s_cbranch_scc1 L_tm_165
  s_waitcnt vmcnt(3)
L_tm_165:
  s_waitcnt vmcnt(4)
L_tf_164:
  s_cbranch_scc1 L_te_166
  s_waitcnt vmcnt(5)
L_te_166:
  s_waitcnt vmcnt(7)
  global_load_dwordx4 v[168:171], v18, s[6:7] nt
  v_xor_b32 v18, 0x102400, v18
  v_mfma_f32_16x16x32_bf16 v[68:71], v[136:139], v[32:35], v[68:71]
  v_add_f32_dpp v80, v65, v64 row_ror:12 row_mask:0xf bank_mask:0xf
  s_nop 1
  v_add_f32_dpp v80, v66, v80 row_ror:8 row_mask:0xf bank_mask:0xf
  s_nop 1
  v_add_f32_dpp v86, v67, v80 row_ror:4 row_mask:0xf bank_mask:0x1
  s_cbranch_vccnz L_tf_167
  s_cbranch_scc1 L_tm_168
  s_waitcnt vmcnt(3)
L_tm_168:
  s_waitcnt vmcnt(4)
L_tf_167:
  s_cbranch_scc1 L_te_169
  s_waitcnt vmcnt(5)
L_te_169:
  s_waitcnt vmcnt(7)
  global_load_dwordx4 v[172:175], v18, s[6:7] nt
  v_xor_b32 v18, 0x2000, v18
  v_mfma_f32_16x16x32_bf16 v[72:75], v[140:143], v[28:31], 0
  s_memrealtime s[58:59]
  ds_read_b64 v[252:253], v2 offset:3112
  s_cbranch_vccnz L_tf_170
  s_cbranch_scc1 L_tm_171
  s_waitcnt vmcnt(3)
L_tm_171:
  s_waitcnt vmcnt(4)
L_tf_170:
  s_cbranch_scc1 L_te_172
  s_waitcnt vmcnt(5)
L_te_172:
  s_waitcnt vmcnt(7)
  global_load_dwordx4 v[176:179], v18, s[6:7] nt
  v_xor_b32 v18, 0x2400, v18
  v_mfma_f32_16x16x32_bf16 v[72:75], v[144:147], v[32:35], v[72:75]
  v_add_f32_dpp v81, v70, v69 row_ror:12 row_mask:0xf bank_mask:0xf
  s_nop 1
  v_add_f32_dpp v81, v71, v81 row_ror:8 row_mask:0xf bank_mask:0xf
  s_nop 1
  v_add_f32_dpp v86, v68, v81 row_ror:4 row_mask:0xf bank_mask:0x2
  s_cbranch_vccnz L_tf_173
  s_cbranch_scc1 L_tm_174
  s_waitcnt vmcnt(3)
L_tm_174:
  s_waitcnt vmcnt(4)
L_tf_173:
  s_cbranch_scc1 L_te_175
  s_waitcnt vmcnt(5)
L_te_175:
  s_waitcnt vmcnt(7)
  global_load_dwordx4 v[180:183], v18, s[6:7] nt
  v_xor_b32 v18, 0x2000, v18
  v_mfma_f32_16x16x32_bf16 v[76:79], v[148:151], v[28:31], 0
  s_waitcnt lgkmcnt(0)
  v_readfirstlane_b32 s54, v252
  v_readfirstlane_b32 s59, v253
  s_sub_u32 s57, s58, s54
  s_mul_i32 s33, s59, 10
  s_lshr_b32 s33, s33, 4
  s_cselect_b32 s57, s57, 0
  s_sub_u32 s57, s57, s33
  s_cmp_gt_i32 s57, 26
  s_cselect_b64 vcc, -1, 0
  s_cselect_b32 s33, s98, s99
  s_cmp_gt_i32 s57, s33
  s_cbranch_vccnz L_tf_176
  s_cbranch_scc1 L_tm_177
  s_waitcnt vmcnt(3)
L_tm_177:
  s_waitcnt vmcnt(4)
L_tf_176:
  s_cbranch_scc1 L_te_178
  s_waitcnt vmcnt(5)
L_te_178:
  s_waitcnt vmcnt(7)
  global_load_dwordx4 v[184:187], v18, s[6:7] nt
  v_xor_b32 v18, 0x196400, v18
  v_mfma_f32_16x16x32_bf16 v[76:79], v[152:155], v[32:35], v[76:79]
  v_add_f32_dpp v82, v75, v74 row_ror:12 row_mask:0xf bank_mask:0xf
  s_nop 1
  v_add_f32_dpp v82, v72, v82 row_ror:8 row_mask:0xf bank_mask:0xf
  s_nop 1
  v_add_f32_dpp v86, v73, v82 row_ror:4 row_mask:0xf bank_mask:0x4
  s_cbranch_vccnz L_tf_179
  s_cbranch_scc1 L_tm_180
  s_waitcnt vmcnt(3)
L_tm_180:
  s_waitcnt vmcnt(4)
L_tf_179:
  s_cbranch_scc1 L_te_181
  s_waitcnt vmcnt(5)
L_te_181:
  s_waitcnt vmcnt(7)
  global_load_dwordx4 v[124:127], v18, s[6:7] nt
  v_xor_b32 v18, 0x2000, v18
  v_mfma_f32_16x16x32_bf16 v[64:67], v[156:159], v[28:31], 0
  s_cbranch_vccnz L_tf_182
  s_cbranch_scc1 L_tm_183
  s_waitcnt vmcnt(3)
L_tm_183:
  s_waitcnt vmcnt(4)
L_tf_182:
  s_cbranch_scc1 L_te_184
  s_waitcnt vmcnt(5)
L_te_184:
  s_waitcnt vmcnt(7)
  global_load_dwordx4 v[128:131], v18, s[6:7] nt
  v_xor_b32 v18, 0x2400, v18
  v_mfma_f32_16x16x32_bf16 v[64:67], v[160:163], v[32:35], v[64:67]
  v_add_f32_dpp v83, v76, v79 row_ror:12 row_mask:0xf bank_mask:0xf
  s_nop 1
  v_add_f32_dpp v83, v77, v83 row_ror:8 row_mask:0xf bank_mask:0xf
  s_nop 1
  v_add_f32_dpp v86, v78, v83 row_ror:4 row_mask:0xf bank_mask:0x8
  s_cbranch_vccnz L_tf_185
  s_cbranch_scc1 L_tm_186
  s_waitcnt vmcnt(3)
L_tm_186:
  s_waitcnt vmcnt(4)
L_tf_185:
  s_cbranch_scc1 L_te_187
  s_waitcnt vmcnt(5)
L_te_187:
  s_waitcnt vmcnt(7)
  global_load_dwordx4 v[132:135], v18, s[6:7] nt
  v_xor_b32 v18, 0x2000, v18
  v_mfma_f32_16x16x32_bf16 v[68:71], v[164:167], v[28:31], 0
  s_cbranch_vccnz L_tf_188
  s_cbranch_scc1 L_tm_189
  s_waitcnt vmcnt(3)
L_tm_189:
  s_waitcnt vmcnt(4)
L_tf_188:
  s_cbranch_scc1 L_te_190
  s_waitcnt vmcnt(5)
L_te_190:
  s_waitcnt vmcnt(7)
  global_load_dwordx4 v[136:139], v18, s[6:7] nt
  v_xor_b32 v18, 0x102400, v18
  v_mfma_f32_16x16x32_bf16 v[68:71], v[168:171], v[32:35], v[68:71]
  v_add_f32_dpp v80, v65, v64 row_ror:12 row_mask:0xf bank_mask:0xf
  s_nop 1
  v_add_f32_dpp v80, v66, v80 row_ror:8 row_mask:0xf bank_mask:0xf
  s_nop 1
  v_add_f32_dpp v87, v67, v80 row_ror:4 row_mask:0xf bank_mask:0x1
  s_cbranch_vccnz L_tf_191
  s_cbranch_scc1 L_tm_192
  s_waitcnt vmcnt(3)
L_tm_192:
  s_waitcnt vmcnt(4)
L_tf_191:
  s_cbranch_scc1 L_te_193
  s_waitcnt vmcnt(5)
L_te_193:
  s_waitcnt vmcnt(7)
  global_load_dwordx4 v[140:143], v18, s[6:7] nt
  v_xor_b32 v18, 0x2000, v18
  v_mfma_f32_16x16x32_bf16 v[72:75], v[172:175], v[28:31], 0
  v_mov_b32 v8, 1
  s_mov_b64 exec, 1
  ds_add_u32 v2, v8 offset:3120
  s_mov_b64 exec, -1
  s_memrealtime s[58:59]
  ds_read_b64 v[252:253], v2 offset:3112
  s_cbranch_vccnz L_tf_194
  s_cbranch_scc1 L_tm_195
  s_waitcnt vmcnt(3)
L_tm_195:
  s_waitcnt vmcnt(4)
L_tf_194:
  s_cbranch_scc1 L_te_196
  s_waitcnt vmcnt(5)
L_te_196:
  s_waitcnt vmcnt(7)
  global_load_dwordx4 v[144:147], v18, s[6:7] nt
  v_xor_b32 v18, 0x2400, v18
  v_mfma_f32_16x16x32_bf16 v[72:75], v[176:179], v[32:35], v[72:75]
  v_add_f32_dpp v81, v70, v69 row_ror:12 row_mask:0xf bank_mask:0xf
  s_nop 1
  v_add_f32_dpp v81, v71, v81 row_ror:8 row_mask:0xf bank_mask:0xf
  s_nop 1
  v_add_f32_dpp v87, v68, v81 row_ror:4 row_mask:0xf bank_mask:0x2
  s_cbranch_vccnz L_tf_197
  s_cbranch_scc1 L_tm_198
  s_waitcnt vmcnt(3)
L_tm_198:
  s_waitcnt vmcnt(4)
L_tf_197:
  s_cbranch_scc1 L_te_199
  s_waitcnt vmcnt(5)
L_te_199:
  s_waitcnt vmcnt(7)
  global_load_dwordx4 v[148:151], v18, s[6:7] nt
  v_xor_b32 v18, 0x2000, v18
  v_mfma_f32_16x16x32_bf16 v[76:79], v[180:183], v[28:31], 0
  s_waitcnt lgkmcnt(0)
  v_readfirstlane_b32 s54, v252
  v_readfirstlane_b32 s59, v253
  s_sub_u32 s57, s58, s54
  s_mul_i32 s33, s59, 11
  s_lshr_b32 s33, s33, 4
  s_cselect_b32 s57, s57, 0
  s_sub_u32 s57, s57, s33
  s_cmp_gt_i32 s57, 26
  s_cselect_b64 vcc, -1, 0
  s_cselect_b32 s33, s98, s99
  s_cmp_gt_i32 s57, s33
  s_cbranch_vccnz L_tf_200
  s_cbranch_scc1 L_tm_201
  s_waitcnt vmcnt(3)
L_tm_201:
  s_waitcnt vmcnt(4)
L_tf_200:
  s_cbranch_scc1 L_te_202
  s_waitcnt vmcnt(5)
L_te_202:
  s_waitcnt vmcnt(7)
  global_load_dwordx4 v[152:155], v18, s[6:7] nt
  v_xor_b32 v18, 0x112400, v18
  v_mfma_f32_16x16x32_bf16 v[76:79], v[184:187], v[32:35], v[76:79]
  v_add_f32_dpp v82, v75, v74 row_ror:12 row_mask:0xf bank_mask:0xf
  s_nop 1
  v_add_f32_dpp v82, v72, v82 row_ror:8 row_mask:0xf bank_mask:0xf
  s_nop 1
  v_add_f32_dpp v87, v73, v82 row_ror:4 row_mask:0xf bank_mask:0x4
  s_cbranch_vccnz L_tf_203
  s_cbranch_scc1 L_tm_204
  s_waitcnt vmcnt(3)
L_tm_204:
  s_waitcnt vmcnt(4)
L_tf_203:
  s_cbranch_scc1 L_te_205
  s_waitcnt vmcnt(5)
L_te_205:
  s_waitcnt vmcnt(7)
  global_load_dwordx4 v[156:159], v18, s[6:7] nt
  v_xor_b32 v18, 0x2000, v18
  v_mfma_f32_16x16x32_bf16 v[64:67], v[124:127], v[28:31], 0
  s_cbranch_vccnz L_tf_206
  s_cbranch_scc1 L_tm_207
  s_waitcnt vmcnt(3)
L_tm_207:
  s_waitcnt vmcnt(4)
L_tf_206:
  s_cbranch_scc1 L_te_208
  s_waitcnt vmcnt(5)
L_te_208:
  s_waitcnt vmcnt(7)
  global_load_dwordx4 v[160:163], v18, s[6:7] nt
  v_xor_b32 v18, 0x2400, v18
  v_mfma_f32_16x16x32_bf16 v[64:67], v[128:131], v[32:35], v[64:67]
  v_add_f32_dpp v83, v76, v79 row_ror:12 row_mask:0xf bank_mask:0xf
  s_nop 1
  v_add_f32_dpp v83, v77, v83 row_ror:8 row_mask:0xf bank_mask:0xf
  s_nop 1
  v_add_f32_dpp v87, v78, v83 row_ror:4 row_mask:0xf bank_mask:0x8
  s_cbranch_vccnz L_tf_209
  s_cbranch_scc1 L_tm_210
  s_waitcnt vmcnt(3)
L_tm_210:
  s_waitcnt vmcnt(4)
L_tf_209:
  s_cbranch_scc1 L_te_211
  s_waitcnt vmcnt(5)
L_te_211:
  s_waitcnt vmcnt(7)
  global_load_dwordx4 v[164:167], v18, s[6:7] nt
  v_xor_b32 v18, 0x2000, v18
  v_mfma_f32_16x16x32_bf16 v[68:71], v[132:135], v[28:31], 0
  s_cbranch_vccnz L_tf_212
  s_cbranch_scc1 L_tm_213
  s_waitcnt vmcnt(3)
L_tm_213:
  s_waitcnt vmcnt(4)
L_tf_212:
  s_cbranch_scc1 L_te_214
  s_waitcnt vmcnt(5)
L_te_214:
  s_waitcnt vmcnt(7)
  global_load_dwordx4 v[168:171], v18, s[6:7] nt
  v_xor_b32 v18, 0x102400, v18
  v_mfma_f32_16x16x32_bf16 v[68:71], v[136:139], v[32:35], v[68:71]
  v_add_f32_dpp v80, v65, v64 row_ror:12 row_mask:0xf bank_mask:0xf
  s_nop 1
  v_add_f32_dpp v80, v66, v80 row_ror:8 row_mask:0xf bank_mask:0xf
  s_nop 1
  v_add_f32_dpp v88, v67, v80 row_ror:4 row_mask:0xf bank_mask:0x1
  s_cbranch_vccnz L_tf_215
  s_cbranch_scc1 L_tm_216
  s_waitcnt vmcnt(3)
L_tm_216:
  s_waitcnt vmcnt(4)
L_tf_215:
  s_cbranch_scc1 L_te_217
  s_waitcnt vmcnt(5)
L_te_217:
  s_waitcnt vmcnt(7)
  global_load_dwordx4 v[172:175], v18, s[6:7] nt
  v_xor_b32 v18, 0x2000, v18
  v_mfma_f32_16x16x32_bf16 v[72:75], v[140:143], v[28:31], 0
  s_memrealtime s[58:59]
  ds_read_b64 v[252:253], v2 offset:3112
  s_cbranch_vccnz L_tf_218
  s_cbranch_scc1 L_tm_219
  s_waitcnt vmcnt(3)
L_tm_219:
  s_waitcnt vmcnt(4)
L_tf_218:
  s_cbranch_scc1 L_te_220
  s_waitcnt vmcnt(5)
L_te_220:
  s_waitcnt vmcnt(7)
  global_load_dwordx4 v[176:179], v18, s[6:7] nt
  v_xor_b32 v18, 0x2400, v18
  v_mfma_f32_16x16x32_bf16 v[72:75], v[144:147], v[32:35], v[72:75]
  v_add_f32_dpp v81, v70, v69 row_ror:12 row_mask:0xf bank_mask:0xf
  s_nop 1
  v_add_f32_dpp v81, v71, v81 row_ror:8 row_mask:0xf bank_mask:0xf
  s_nop 1
  v_add_f32_dpp v88, v68, v81 row_ror:4 row_mask:0xf bank_mask:0x2
  s_cbranch_vccnz L_tf_221
  s_cbranch_scc1 L_tm_222
  s_waitcnt vmcnt(3)
L_tm_222:
  s_waitcnt vmcnt(4)
L_tf_221:
  s_cbranch_scc1 L_te_223
  s_waitcnt vmcnt(5)
L_te_223:
  s_waitcnt vmcnt(7)
  global_load_dwordx4 v[180:183], v18, s[6:7] nt
  v_xor_b32 v18, 0x2000, v18
  v_mfma_f32_16x16x32_bf16 v[76:79], v[148:151], v[28:31], 0
  s_waitcnt lgkmcnt(0)
  v_readfirstlane_b32 s54, v252
  v_readfirstlane_b32 s59, v253
  s_sub_u32 s57, s58, s54
  s_mul_i32 s33, s59, 12
  s_lshr_b32 s33, s33, 4
  s_cselect_b32 s57, s57, 0
  s_sub_u32 s57, s57, s33
  s_cmp_gt_i32 s57, 26
  s_cselect_b64 vcc, -1, 0
  s_cselect_b32 s33, s98, s99
  s_cmp_gt_i32 s57, s33
  s_cbranch_vccnz L_tf_224
  s_cbranch_scc1 L_tm_225
  s_waitcnt vmcnt(3)
L_tm_225:
  s_waitcnt vmcnt(4)
L_tf_224:
  s_cbranch_scc1 L_te_226
  s_waitcnt vmcnt(5)
L_te_226:
  s_waitcnt vmcnt(7)
  global_load_dwordx4 v[184:187], v18, s[6:7] nt
  v_xor_b32 v18, 0x192400, v18
  v_mfma_f32_16x16x32_bf16 v[76:79], v[152:155], v[32:35], v[76:79]
  v_add_f32_dpp v82, v75, v74 row_ror:12 row_mask:0xf bank_mask:0xf
  s_nop 1
  v_add_f32_dpp v82, v72, v82 row_ror:8 row_mask:0xf bank_mask:0xf
  s_nop 1
  v_add_f32_dpp v88, v73, v82 row_ror:4 row_mask:0xf bank_mask:0x4
  s_cbranch_vccnz L_tf_227
  s_cbranch_scc1 L_tm_228
  s_waitcnt vmcnt(3)
L_tm_228:
  s_waitcnt vmcnt(4)
L_tf_227:
  s_cbranch_scc1 L_te_229
  s_waitcnt vmcnt(5)
L_te_229:
  s_waitcnt vmcnt(7)
  global_load_dwordx4 v[124:127], v18, s[6:7] nt
  v_xor_b32 v18, 0x2000, v18
  v_mfma_f32_16x16x32_bf16 v[64:67], v[156:159], v[28:31], 0
  s_cbranch_vccnz L_tf_230
  s_cbranch_scc1 L_tm_231
  s_waitcnt vmcnt(3)
L_tm_231:
  s_waitcnt vmcnt(4)
L_tf_230:
  s_cbranch_scc1 L_te_232
  s_waitcnt vmcnt(5)
L_te_232:
  s_waitcnt vmcnt(7)
  global_load_dwordx4 v[128:131], v18, s[6:7] nt
  v_xor_b32 v18, 0x2400, v18
  v_mfma_f32_16x16x32_bf16 v[64:67], v[160:163], v[32:35], v[64:67]
  v_add_f32_dpp v83, v76, v79 row_ror:12 row_mask:0xf bank_mask:0xf
  s_nop 1
  v_add_f32_dpp v83, v77, v83 row_ror:8 row_mask:0xf bank_mask:0xf
  s_nop 1
  v_add_f32_dpp v88, v78, v83 row_ror:4 row_mask:0xf bank_mask:0x8
  s_cbranch_vccnz L_tf_233
  s_cbranch_scc1 L_tm_234
  s_waitcnt vmcnt(3)
L_tm_234:
  s_waitcnt vmcnt(4)
L_tf_233:
  s_cbranch_scc1 L_te_235
  s_waitcnt vmcnt(5)
L_te_235:
  s_waitcnt vmcnt(7)
  global_load_dwordx4 v[132:135], v18, s[6:7] nt
  v_xor_b32 v18, 0x2000, v18
  v_mfma_f32_16x16x32_bf16 v[68:71], v[164:167], v[28:31], 0
  s_cbranch_vccnz L_tf_236
  s_cbranch_scc1 L_tm_237
  s_waitcnt vmcnt(3)
L_tm_237:
  s_waitcnt vmcnt(4)
L_tf_236:
  s_cbranch_scc1 L_te_238
  s_waitcnt vmcnt(5)
L_te_238:
  s_waitcnt vmcnt(7)
  global_load_dwordx4 v[136:139], v18, s[6:7] nt
  v_xor_b32 v18, 0x102400, v18
  v_mfma_f32_16x16x32_bf16 v[68:71], v[168:171], v[32:35], v[68:71]
  v_add_f32_dpp v80, v65, v64 row_ror:12 row_mask:0xf bank_mask:0xf
  s_nop 1
  v_add_f32_dpp v80, v66, v80 row_ror:8 row_mask:0xf bank_mask:0xf
  s_nop 1
  v_add_f32_dpp v89, v67, v80 row_ror:4 row_mask:0xf bank_mask:0x1
  s_cbranch_vccnz L_tf_239
  s_cbranch_scc1 L_tm_240
  s_waitcnt vmcnt(3)
L_tm_240:
  s_waitcnt vmcnt(4)
L_tf_239:
  s_cbranch_scc1 L_te_241
  s_waitcnt vmcnt(5)
L_te_241:
  s_waitcnt vmcnt(7)
  global_load_dwordx4 v[140:143], v18, s[6:7] nt
  v_xor_b32 v18, 0x2000, v18
  v_mfma_f32_16x16x32_bf16 v[72:75], v[172:175], v[28:31], 0
  v_xor_b32 v254, s44, v3
  v_bfe_i32 v7, v1, 2, 1
  v_and_b32 v7, 0x100, v7
  v_xor_b32 v254, v254, v7
  v_bfe_i32 v7, v1, 3, 1
  v_and_b32 v7, 0x200, v7
  v_xor_b32 v254, v254, v7
  s_memrealtime s[58:59]
  ds_read_b64 v[252:253], v2 offset:3112
  s_cmp_gt_i32 s57, 26
  s_cselect_b64 vcc, -1, 0
  s_cselect_b32 s33, s98, s99
  s_cmp_gt_i32 s57, s33
  s_cbranch_vccnz L_tf_242
  s_cbranch_scc1 L_tm_243
  s_waitcnt vmcnt(3)
L_tm_243:
  s_waitcnt vmcnt(4)
L_tf_242:
  s_cbranch_scc1 L_te_244
  s_waitcnt vmcnt(5)
L_te_244:
  s_waitcnt vmcnt(7)
  global_load_dwordx4 v[144:147], v18, s[6:7] nt
  v_xor_b32 v18, 0x2400, v18
  v_mfma_f32_16x16x32_bf16 v[72:75], v[176:179], v[32:35], v[72:75]
  v_add_f32_dpp v81, v70, v69 row_ror:12 row_mask:0xf bank_mask:0xf
  s_nop 1
  v_add_f32_dpp v81, v71, v81 row_ror:8 row_mask:0xf bank_mask:0xf
  s_nop 1
  v_add_f32_dpp v89, v68, v81 row_ror:4 row_mask:0xf bank_mask:0x2
  s_cbranch_vccnz L_tf_245
  s_cbranch_scc1 L_tm_246
  s_waitcnt vmcnt(3)
L_tm_246:
  s_waitcnt vmcnt(4)
L_tf_245:
  s_cbranch_scc1 L_te_247
  s_waitcnt vmcnt(5)
L_te_247:
  s_waitcnt vmcnt(7)
  global_load_dwordx4 v[148:151], v18, s[6:7] nt
  v_xor_b32 v18, 0x2000, v18
  v_mfma_f32_16x16x32_bf16 v[76:79], v[180:183], v[28:31], 0
  s_waitcnt lgkmcnt(0)
  v_readfirstlane_b32 s54, v252
  v_readfirstlane_b32 s59, v253
  s_sub_u32 s57, s58, s54
  s_mul_i32 s33, s59, 13
  s_lshr_b32 s33, s33, 4
  s_cselect_b32 s57, s57, 0
  s_sub_u32 s57, s57, s33
  s_cmp_gt_i32 s57, 26
  s_cselect_b64 vcc, -1, 0
  s_cselect_b32 s33, s98, s99
  s_cmp_gt_i32 s57, s33
  s_cbranch_vccnz L_tf_248
  s_cbranch_scc1 L_tm_249
  s_waitcnt vmcnt(3)
L_tm_249:
  s_waitcnt vmcnt(4)
L_tf_248:
  s_cbranch_scc1 L_te_250
  s_waitcnt vmcnt(5)
L_te_250:
  s_waitcnt vmcnt(7)
  global_load_dwordx4 v[152:155], v18, s[6:7] nt
  v_xor_b32 v18, 0x112400, v18
  v_mfma_f32_16x16x32_bf16 v[76:79], v[184:187], v[32:35], v[76:79]
  v_add_f32_dpp v82, v75, v74 row_ror:12 row_mask:0xf bank_mask:0xf
  s_nop 1
  v_add_f32_dpp v82, v72, v82 row_ror:8 row_mask:0xf bank_mask:0xf
  s_nop 1
  v_add_f32_dpp v89, v73, v82 row_ror:4 row_mask:0xf bank_mask:0x4
  s_cbranch_vccnz L_tf_251
  s_cbranch_scc1 L_tm_252
  s_waitcnt vmcnt(3)
L_tm_252:
  s_waitcnt vmcnt(4)
L_tf_251:
  s_cbranch_scc1 L_te_253
  s_waitcnt vmcnt(5)
L_te_253:
  s_waitcnt vmcnt(7)
  global_load_dwordx4 v[156:159], v18, s[6:7] nt
  v_xor_b32 v18, 0x2000, v18
  v_mfma_f32_16x16x32_bf16 v[64:67], v[124:127], v[28:31], 0
  s_cbranch_vccnz L_tf_254
  s_cbranch_scc1 L_tm_255
  s_waitcnt vmcnt(3)
L_tm_255:
  s_waitcnt vmcnt(4)
L_tf_254:
  s_cbranch_scc1 L_te_256
  s_waitcnt vmcnt(5)
L_te_256:
  s_waitcnt vmcnt(7)
  global_load_dwordx4 v[160:163], v18, s[6:7] nt
  v_xor_b32 v18, 0x2400, v18
  v_mfma_f32_16x16x32_bf16 v[64:67], v[128:131], v[32:35], v[64:67]
  v_add_f32_dpp v83, v76, v79 row_ror:12 row_mask:0xf bank_mask:0xf
  s_nop 1
  v_add_f32_dpp v83, v77, v83 row_ror:8 row_mask:0xf bank_mask:0xf
  s_nop 1
  v_add_f32_dpp v89, v78, v83 row_ror:4 row_mask:0xf bank_mask:0x8
  s_cbranch_vccnz L_tf_257
  s_cbranch_scc1 L_tm_258
  s_waitcnt vmcnt(3)
L_tm_258:
  s_waitcnt vmcnt(4)
L_tf_257:
  s_cbranch_scc1 L_te_259
  s_waitcnt vmcnt(5)
L_te_259:
  s_waitcnt vmcnt(7)
  global_load_dwordx4 v[164:167], v18, s[6:7] nt
  v_xor_b32 v18, 0x2000, v18
  v_mfma_f32_16x16x32_bf16 v[68:71], v[132:135], v[28:31], 0
  s_cbranch_vccnz L_tf_260
  s_cbranch_scc1 L_tm_261
  s_waitcnt vmcnt(3)
L_tm_261:
  s_waitcnt vmcnt(4)
L_tf_260:
  s_cbranch_scc1 L_te_262
  s_waitcnt vmcnt(5)
L_te_262:
  s_waitcnt vmcnt(7)
  global_load_dwordx4 v[168:171], v18, s[6:7] nt
  v_xor_b32 v18, 0x102400, v18
  v_mfma_f32_16x16x32_bf16 v[68:71], v[136:139], v[32:35], v[68:71]
  v_add_f32_dpp v80, v65, v64 row_ror:12 row_mask:0xf bank_mask:0xf
  s_nop 1
  v_add_f32_dpp v80, v66, v80 row_ror:8 row_mask:0xf bank_mask:0xf
  s_nop 1
  v_add_f32_dpp v90, v67, v80 row_ror:4 row_mask:0xf bank_mask:0x1
  s_cbranch_vccnz L_tf_263
  s_cbranch_scc1 L_tm_264
  s_waitcnt vmcnt(3)
L_tm_264:
  s_waitcnt vmcnt(4)
L_tf_263:
  s_cbranch_scc1 L_te_265
  s_waitcnt vmcnt(5)
L_te_265:
  s_waitcnt vmcnt(7)
  global_load_dwordx4 v[172:175], v18, s[6:7] nt
  v_xor_b32 v18, 0x2000, v18
  v_mfma_f32_16x16x32_bf16 v[72:75], v[140:143], v[28:31], 0
  s_memrealtime s[58:59]
  ds_read_b64 v[252:253], v2 offset:3112
  s_cbranch_vccnz L_tf_266
  s_cbranch_scc1 L_tm_267
  s_waitcnt vmcnt(3)
L_tm_267:
  s_waitcnt vmcnt(4)
L_tf_266:
  s_cbranch_scc1 L_te_268
  s_waitcnt vmcnt(5)
L_te_268:
  s_waitcnt vmcnt(7)
  global_load_dwordx4 v[176:179], v18, s[6:7] nt
  v_xor_b32 v18, 0x2400, v18
  v_mfma_f32_16x16x32_bf16 v[72:75], v[144:147], v[32:35], v[72:75]
  v_add_f32_dpp v81, v70, v69 row_ror:12 row_mask:0xf bank_mask:0xf
  s_nop 1
  v_add_f32_dpp v81, v71, v81 row_ror:8 row_mask:0xf bank_mask:0xf
  s_nop 1
  v_add_f32_dpp v90, v68, v81 row_ror:4 row_mask:0xf bank_mask:0x2
  s_cbranch_vccnz L_tf_269
  s_cbranch_scc1 L_tm_270
  s_waitcnt vmcnt(3)
L_tm_270:
  s_waitcnt vmcnt(4)
L_tf_269:
  s_cbranch_scc1 L_te_271
  s_waitcnt vmcnt(5)
L_te_271:
  s_waitcnt vmcnt(7)
  global_load_dwordx4 v[180:183], v18, s[6:7] nt
  v_xor_b32 v18, 0x2000, v18
  v_mfma_f32_16x16x32_bf16 v[76:79], v[148:151], v[28:31], 0
  s_waitcnt lgkmcnt(0)
  v_readfirstlane_b32 s54, v252
  v_readfirstlane_b32 s59, v253
  s_sub_u32 s57, s58, s54
  s_mul_i32 s33, s59, 14
  s_lshr_b32 s33, s33, 4
  s_cselect_b32 s57, s57, 0
  s_sub_u32 s57, s57, s33
  s_cmp_gt_i32 s57, 26
  s_cselect_b64 vcc, -1, 0
  s_cselect_b32 s33, s98, s99
  s_cmp_gt_i32 s57, s33
  s_cbranch_vccnz L_tf_272
  s_cbranch_scc1 L_tm_273
  s_waitcnt vmcnt(3)
L_tm_273:
  s_waitcnt vmcnt(4)
L_tf_272:
  s_cbranch_scc1 L_te_274
  s_waitcnt vmcnt(5)
L_te_274:
  s_waitcnt vmcnt(7)
  global_load_dwordx4 v[184:187], v18, s[6:7] nt
  v_mov_b32 v18, v254
  v_mfma_f32_16x16x32_bf16 v[76:79], v[152:155], v[32:35], v[76:79]
  v_add_f32_dpp v82, v75, v74 row_ror:12 row_mask:0xf bank_mask:0xf
  s_nop 1
  v_add_f32_dpp v82, v72, v82 row_ror:8 row_mask:0xf bank_mask:0xf
  s_nop 1
  v_add_f32_dpp v90, v73, v82 row_ror:4 row_mask:0xf bank_mask:0x4
  s_cbranch_vccnz L_tf_275
  s_cbranch_scc1 L_tm_276
  s_waitcnt vmcnt(3)
L_tm_276:
  s_waitcnt vmcnt(4)
L_tf_275:
  s_cbranch_scc1 L_te_277
  s_waitcnt vmcnt(5)
L_te_277:
  s_waitcnt vmcnt(7)
  global_load_dwordx4 v[124:127], v18, s[16:17] nt
  v_xor_b32 v18, 0x2000, v18
  v_mfma_f32_16x16x32_bf16 v[64:67], v[156:159], v[28:31], 0
  s_cbranch_vccnz L_tf_278
  s_cbranch_scc1 L_tm_279
  s_waitcnt vmcnt(3)
L_tm_279:
  s_waitcnt vmcnt(4)
L_tf_278:
  s_cbranch_scc1 L_te_280
  s_waitcnt vmcnt(5)
L_te_280:
  s_waitcnt vmcnt(7)
  global_load_dwordx4 v[128:131], v18, s[16:17] nt
  v_xor_b32 v18, 0x3000, v18
  v_mfma_f32_16x16x32_bf16 v[64:67], v[160:163], v[32:35], v[64:67]
  v_add_f32_dpp v83, v76, v79 row_ror:12 row_mask:0xf bank_mask:0xf
  s_nop 1
  v_add_f32_dpp v83, v77, v83 row_ror:8 row_mask:0xf bank_mask:0xf
  s_nop 1
  v_add_f32_dpp v90, v78, v83 row_ror:4 row_mask:0xf bank_mask:0x8
  s_cbranch_vccnz L_tf_281
  s_cbranch_scc1 L_tm_282
  s_waitcnt vmcnt(3)
L_tm_282:
  s_waitcnt vmcnt(4)
L_tf_281:
  s_cbranch_scc1 L_te_283
  s_waitcnt vmcnt(5)
L_te_283:
  s_waitcnt vmcnt(7)
  global_load_dwordx4 v[132:135], v18, s[16:17] nt
  v_xor_b32 v18, 0x2000, v18
  v_mfma_f32_16x16x32_bf16 v[68:71], v[164:167], v[28:31], 0
  s_cbranch_vccnz L_tf_284
  s_cbranch_scc1 L_tm_285
  s_waitcnt vmcnt(3)
L_tm_285:
  s_waitcnt vmcnt(4)
L_tf_284:
  s_cbranch_scc1 L_te_286
  s_waitcnt vmcnt(5)
L_te_286:
  s_waitcnt vmcnt(7)
  global_load_dwordx4 v[136:139], v18, s[16:17] nt
  v_xor_b32 v18, 0x23000, v18
  v_mfma_f32_16x16x32_bf16 v[68:71], v[168:171], v[32:35], v[68:71]
  v_add_f32_dpp v80, v65, v64 row_ror:12 row_mask:0xf bank_mask:0xf
  s_nop 1
  v_add_f32_dpp v80, v66, v80 row_ror:8 row_mask:0xf bank_mask:0xf
  s_nop 1
  v_add_f32_dpp v91, v67, v80 row_ror:4 row_mask:0xf bank_mask:0x1
  s_cbranch_vccnz L_tf_287
  s_cbranch_scc1 L_tm_288
  s_waitcnt vmcnt(3)
L_tm_288:
  s_waitcnt vmcnt(4)
L_tf_287:
  s_cbranch_scc1 L_te_289
  s_waitcnt vmcnt(5)
L_te_289:
  s_waitcnt vmcnt(7)
  global_load_dwordx4 v[140:143], v18, s[16:17] nt
  v_xor_b32 v18, 0x2000, v18
  v_mfma_f32_16x16x32_bf16 v[72:75], v[172:175], v[28:31], 0
  v_and_b32 v254, 0xf0, v4
  v_xor_b32 v254, s44, v254
  v_bfe_i32 v7, v1, 4, 1
  v_and_b32 v7, 0x100, v7
  v_xor_b32 v254, v254, v7
  v_bfe_i32 v7, v1, 5, 1
  v_and_b32 v7, 0x200, v7
  v_xor_b32 v254, v254, v7
  s_memrealtime s[58:59]
  ds_read_b64 v[252:253], v2 offset:3112
  s_cmp_gt_i32 s57, 26
  s_cselect_b64 vcc, -1, 0
  s_cselect_b32 s33, s98, s99
  s_cmp_gt_i32 s57, s33
  s_cbranch_vccnz L_tf_290
  s_cbranch_scc1 L_tm_291
  s_waitcnt vmcnt(3)
L_tm_291:
  s_waitcnt vmcnt(4)
L_tf_290:
  s_cbranch_scc1 L_te_292
  s_waitcnt vmcnt(5)
L_te_292:
  s_waitcnt vmcnt(7)
  global_load_dwordx4 v[144:147], v18, s[16:17] nt
  v_xor_b32 v18, 0x3000, v18
  v_mfma_f32_16x16x32_bf16 v[72:75], v[176:179], v[32:35], v[72:75]
  v_add_f32_dpp v81, v70, v69 row_ror:12 row_mask:0xf bank_mask:0xf
  s_nop 1
  v_add_f32_dpp v81, v71, v81 row_ror:8 row_mask:0xf bank_mask:0xf
  s_nop 1
  v_add_f32_dpp v91, v68, v81 row_ror:4 row_mask:0xf bank_mask:0x2
  s_cbranch_vccnz L_tf_293
  s_cbranch_scc1 L_tm_294
  s_waitcnt vmcnt(3)
L_tm_294:
  s_waitcnt vmcnt(4)
L_tf_293:
  s_cbranch_scc1 L_te_295
  s_waitcnt vmcnt(5)
L_te_295:
  s_waitcnt vmcnt(7)
  global_load_dwordx4 v[148:151], v18, s[16:17] nt
  v_xor_b32 v18, 0x2000, v18
  v_mfma_f32_16x16x32_bf16 v[76:79], v[180:183], v[28:31], 0
  s_waitcnt lgkmcnt(0)
  v_readfirstlane_b32 s54, v252
  v_readfirstlane_b32 s59, v253
  s_sub_u32 s57, s58, s54
  s_mul_i32 s33, s59, 15
  s_lshr_b32 s33, s33, 4
  s_cselect_b32 s57, s57, 0
  s_sub_u32 s57, s57, s33
  s_cmp_lg_u32 s55, 0
  s_cbranch_scc1 L_opt_296
  s_add_u32 s58, s58, s62
  s_lshl_b32 s33, s3, 8
  s_add_u32 s33, s33, 156160
  v_mov_b32 v7, s33
  v_mov_b32 v8, s58
  s_mov_b64 exec, 1
  global_store_dword v7, v8, s[28:29] sc1
  s_mov_b64 exec, -1
  s_nop 1
L_opt_296:
  s_cmp_gt_i32 s57, 26
  s_cselect_b64 vcc, -1, 0
  s_cselect_b32 s33, s98, s99
  s_cmp_gt_i32 s57, s33
  s_cbranch_vccnz L_tf_297
  s_cbranch_scc1 L_tm_298
  s_waitcnt vmcnt(3)
L_tm_298:
  s_waitcnt vmcnt(4)
L_tf_297:
  s_cbranch_scc1 L_te_299
  s_waitcnt vmcnt(5)
L_te_299:
  s_waitcnt vmcnt(7)
  global_load_dwordx4 v[152:155], v18, s[16:17] nt
  v_xor_b32 v18, 0xa3000, v18
  v_mfma_f32_16x16x32_bf16 v[76:79], v[184:187], v[32:35], v[76:79]
  v_add_f32_dpp v82, v75, v74 row_ror:12 row_mask:0xf bank_mask:0xf
  s_nop 1
  v_add_f32_dpp v82, v72, v82 row_ror:8 row_mask:0xf bank_mask:0xf
  s_nop 1
  v_add_f32_dpp v91, v73, v82 row_ror:4 row_mask:0xf bank_mask:0x4
  ds_read_b128 v[28:31], v5 offset:2560
  s_waitcnt lgkmcnt(0)
  v_cndmask_b32 v32, 0, v28, s[42:43]
  v_cndmask_b32 v33, 0, v29, s[42:43]
  v_cndmask_b32 v34, 0, v30, s[42:43]
  v_cndmask_b32 v35, 0, v31, s[42:43]
  v_cndmask_b32 v28, v28, 0, s[42:43]
  v_cndmask_b32 v29, v29, 0, s[42:43]
  v_cndmask_b32 v30, v30, 0, s[42:43]
  v_cndmask_b32 v31, v31, 0, s[42:43]
  s_cbranch_vccnz L_tf_300
  s_cbranch_scc1 L_tm_301
  s_waitcnt vmcnt(3)
L_tm_301:
  s_waitcnt vmcnt(4)
L_tf_300:
  s_cbranch_scc1 L_te_302
  s_waitcnt vmcnt(5)
L_te_302:
  s_waitcnt vmcnt(7)
  global_load_dwordx4 v[156:159], v18, s[16:17] nt
  v_xor_b32 v18, 0x2000, v18
  v_mfma_f32_16x16x32_bf16 v[64:67], v[124:127], v[28:31], 0
  s_cbranch_vccnz L_tf_303
  s_cbranch_scc1 L_tm_304
  s_waitcnt vmcnt(3)
L_tm_304:
  s_waitcnt vmcnt(4)
L_tf_303:
  s_cbranch_scc1 L_te_305
  s_waitcnt vmcnt(5)
L_te_305:
  s_waitcnt vmcnt(7)
  global_load_dwordx4 v[160:163], v18, s[16:17] nt
  v_xor_b32 v18, 0x3000, v18
  v_mfma_f32_16x16x32_bf16 v[64:67], v[128:131], v[32:35], v[64:67]
  v_add_f32_dpp v83, v76, v79 row_ror:12 row_mask:0xf bank_mask:0xf
  s_nop 1
  v_add_f32_dpp v83, v77, v83 row_ror:8 row_mask:0xf bank_mask:0xf
  s_nop 1
  v_add_f32_dpp v91, v78, v83 row_ror:4 row_mask:0xf bank_mask:0x8
  global_load_dwordx4 v[164:167], v18, s[16:17] nt
  v_xor_b32 v18, 0x2000, v18
  v_max3_f32 v7, v84, v85, v86
  v_max3_f32 v8, v87, v88, v89
  v_max3_f32 v7, v7, v90, v91
  v_max_f32 v7, v7, v8
  s_nop 1
  v_max_f32_dpp v7, v7, v7 row_ror:2 row_mask:0xf bank_mask:0xf
  s_nop 1
  v_max_f32_dpp v7, v7, v7 row_ror:4 row_mask:0xf bank_mask:0xf
  s_nop 1
  v_max_f32_dpp v7, v7, v7 row_ror:8 row_mask:0xf bank_mask:0xf
  v_mov_b32 v8, v7
  s_nop 1
  v_permlane16_swap_b32 v7, v8
  v_max_f32 v7, v7, v8
  v_mov_b32 v8, v7
  s_nop 1
  v_permlane32_swap_b32 v7, v8
  v_max_f32 v7, v7, v8
  v_mul_f32 v7, s40, v7
  v_max_f32 v7, v7, v9
  v_sub_f32 v8, v9, v7
  v_exp_f32 v8, v8
  v_mov_b32 v9, v7
  v_mul_f32 v10, v10, v8
  v_fma_f32 v84, v84, s40, -v9
  v_fma_f32 v85, v85, s40, -v9
  v_fma_f32 v86, v86, s40, -v9
  v_fma_f32 v87, v87, s40, -v9
  v_fma_f32 v88, v88, s40, -v9
  v_fma_f32 v89, v89, s40, -v9
  v_fma_f32 v90, v90, s40, -v9
  v_fma_f32 v91, v91, s40, -v9
  v_exp_f32 v84, v84
  v_exp_f32 v85, v85
  v_exp_f32 v86, v86
  v_exp_f32 v87, v87
  v_exp_f32 v88, v88
  v_exp_f32 v89, v89
  v_exp_f32 v90, v90
  v_exp_f32 v91, v91
  v_cvt_pk_bf16_f32 v52, v84, v85
  v_cvt_pk_bf16_f32 v53, v86, v87
  v_cvt_pk_bf16_f32 v54, v88, v89
  v_cvt_pk_bf16_f32 v55, v90, v91
  v_add_f32 v10, v84, v10
  v_add_f32 v10, v85, v10
  v_add_f32 v10, v86, v10
  v_add_f32 v10, v87, v10
  v_add_f32 v10, v88, v10
  v_add_f32 v10, v89, v10
  v_add_f32 v10, v90, v10
  v_add_f32 v10, v91, v10
  s_cmp_gt_i32 s57, 26
  s_cselect_b64 vcc, -1, 0
  s_cselect_b32 s33, s98, s99
  s_cmp_gt_i32 s57, s33
  s_waitcnt vmcnt(8)
  v_mfma_f32_16x16x32_bf16 v[68:71], v[132:135], v[28:31], 0
  s_cbranch_vccnz L_tf_306
  s_cbranch_scc1 L_tm_307
  s_waitcnt vmcnt(3)
L_tm_307:
  s_waitcnt vmcnt(4)
L_tf_306:
  s_cbranch_scc1 L_te_308
  s_waitcnt vmcnt(5)
L_te_308:
  s_waitcnt vmcnt(7)
  global_load_dwordx4 v[168:171], v18, s[16:17] nt
  v_xor_b32 v18, 0x23000, v18
  v_mfma_f32_16x16x32_bf16 v[68:71], v[136:139], v[32:35], v[68:71]
  v_add_f32_dpp v80, v65, v64 row_ror:12 row_mask:0xf bank_mask:0xf
  s_nop 1
  v_add_f32_dpp v80, v66, v80 row_ror:8 row_mask:0xf bank_mask:0xf
  s_nop 1
  v_add_f32_dpp v84, v67, v80 row_ror:4 row_mask:0xf bank_mask:0x1
  s_cbranch_vccnz L_tf_309
  s_cbranch_scc1 L_tm_310
  s_waitcnt vmcnt(3)
L_tm_310:
  s_waitcnt vmcnt(4)
L_tf_309:
  s_cbranch_scc1 L_te_311
  s_waitcnt vmcnt(5)
L_te_311:
  s_waitcnt vmcnt(7)
  global_load_dwordx4 v[172:175], v18, s[16:17] nt
  v_xor_b32 v18, 0x2000, v18
  v_mfma_f32_16x16x32_bf16 v[72:75], v[140:143], v[28:31], 0
  s_memrealtime s[58:59]
  ds_read_b64 v[252:253], v2 offset:3112
  s_cbranch_vccnz L_tf_312
  s_cbranch_scc1 L_tm_313
  s_waitcnt vmcnt(3)
L_tm_313:
  s_waitcnt vmcnt(4)
L_tf_312:
  s_cbranch_scc1 L_te_314
  s_waitcnt vmcnt(5)
L_te_314:
  s_waitcnt vmcnt(7)
  global_load_dwordx4 v[176:179], v18, s[16:17] nt
  v_xor_b32 v18, 0x3000, v18
  v_mfma_f32_16x16x32_bf16 v[72:75], v[144:147], v[32:35], v[72:75]
  v_add_f32_dpp v81, v70, v69 row_ror:12 row_mask:0xf bank_mask:0xf
  s_nop 1
  v_add_f32_dpp v81, v71, v81 row_ror:8 row_mask:0xf bank_mask:0xf
  s_nop 1
  v_add_f32_dpp v84, v68, v81 row_ror:4 row_mask:0xf bank_mask:0x2
  s_cbranch_vccnz L_tf_315
  s_cbranch_scc1 L_tm_316
  s_waitcnt vmcnt(3)
L_tm_316:
  s_waitcnt vmcnt(4)
L_tf_315:
  s_cbranch_scc1 L_te_317
  s_waitcnt vmcnt(5)
L_te_317:
  s_waitcnt vmcnt(7)
  global_load_dwordx4 v[180:183], v18, s[16:17] nt
  v_xor_b32 v18, 0x2000, v18
  v_mfma_f32_16x16x32_bf16 v[76:79], v[148:151], v[28:31], 0
  s_waitcnt lgkmcnt(0)
  v_readfirstlane_b32 s54, v252
  v_readfirstlane_b32 s59, v253
  s_sub_u32 s57, s58, s54
  s_mul_i32 s33, s59, 16
  s_lshr_b32 s33, s33, 4
  s_cselect_b32 s57, s57, 0
  s_sub_u32 s57, s57, s33
  s_cmp_gt_i32 s57, 26
  s_cselect_b64 vcc, -1, 0
  s_cselect_b32 s33, s98, s99
  s_cmp_gt_i32 s57, s33
  s_cbranch_vccnz L_tf_318
  s_cbranch_scc1 L_tm_319
  s_waitcnt vmcnt(3)
L_tm_319:
  s_waitcnt vmcnt(4)
L_tf_318:
  s_cbranch_scc1 L_te_320
  s_waitcnt vmcnt(5)
L_te_320:
  s_waitcnt vmcnt(7)
  global_load_dwordx4 v[184:187], v18, s[16:17] nt
  v_mov_b32 v18, v254
  v_mfma_f32_16x16x32_bf16 v[76:79], v[152:155], v[32:35], v[76:79]
  v_add_f32_dpp v82, v75, v74 row_ror:12 row_mask:0xf bank_mask:0xf
  s_nop 1
  v_add_f32_dpp v82, v72, v82 row_ror:8 row_mask:0xf bank_mask:0xf
  s_nop 1
  v_add_f32_dpp v84, v73, v82 row_ror:4 row_mask:0xf bank_mask:0x4
  s_cbranch_vccnz L_tf_321
  s_cbranch_scc1 L_tm_322
  s_waitcnt vmcnt(3)
L_tm_322:
  s_waitcnt vmcnt(4)
L_tf_321:
  s_cbranch_scc1 L_te_323
  s_waitcnt vmcnt(5)
L_te_323:
  s_waitcnt vmcnt(7)
  global_load_dwordx4 v[124:127], v18, s[18:19] nt
  v_xor_b32 v18, 0x2000, v18
  v_mfma_f32_16x16x32_bf16 v[64:67], v[156:159], v[28:31], 0
  s_cbranch_vccnz L_tf_324
  s_cbranch_scc1 L_tm_325
  s_waitcnt vmcnt(3)
L_tm_325:
  s_waitcnt vmcnt(4)
L_tf_324:
  s_cbranch_scc1 L_te_326
  s_waitcnt vmcnt(5)
L_te_326:
  s_waitcnt vmcnt(7)
  global_load_dwordx4 v[128:131], v18, s[18:19] nt
  v_xor_b32 v18, 0x3000, v18
  v_mfma_f32_16x16x32_bf16 v[64:67], v[160:163], v[32:35], v[64:67]
  v_add_f32_dpp v83, v76, v79 row_ror:12 row_mask:0xf bank_mask:0xf
  s_nop 1
  v_add_f32_dpp v83, v77, v83 row_ror:8 row_mask:0xf bank_mask:0xf
  s_nop 1
  v_add_f32_dpp v84, v78, v83 row_ror:4 row_mask:0xf bank_mask:0x8
  s_cbranch_vccnz L_tf_327
  s_cbranch_scc1 L_tm_328
  s_waitcnt vmcnt(3)
L_tm_328:
  s_waitcnt vmcnt(4)
L_tf_327:
  s_cbranch_scc1 L_te_329
  s_waitcnt vmcnt(5)
L_te_329:
  s_waitcnt vmcnt(7)
  global_load_dwordx4 v[132:135], v18, s[18:19] nt
  v_xor_b32 v18, 0x2000, v18
  v_mfma_f32_16x16x32_bf16 v[68:71], v[164:167], v[28:31], 0
  v_add_f32_dpp v10, v10, v10 row_ror:2 row_mask:0xf bank_mask:0xf
  s_nop 1
  v_add_f32_dpp v10, v10, v10 row_ror:4 row_mask:0xf bank_mask:0xf
  s_nop 1
  v_add_f32_dpp v10, v10, v10 row_ror:8 row_mask:0xf bank_mask:0xf
  v_mov_b32 v7, v10
  s_nop 1
  v_permlane16_swap_b32 v10, v7
  v_add_f32 v10, v10, v7
  v_mov_b32 v7, v10
  s_nop 1
  v_permlane32_swap_b32 v10, v7
  v_add_f32 v10, v10, v7
  s_cmp_gt_i32 s57, 26
  s_cselect_b64 vcc, -1, 0
  s_cselect_b32 s33, s98, s99
  s_cmp_gt_i32 s57, s33
  s_cbranch_vccnz L_tf_330
  s_cbranch_scc1 L_tm_331
  s_waitcnt vmcnt(3)
L_tm_331:
  s_waitcnt vmcnt(4)
L_tf_330:
  s_cbranch_scc1 L_te_332
  s_waitcnt vmcnt(5)
L_te_332:
  s_waitcnt vmcnt(7)
  global_load_dwordx4 v[136:139], v18, s[18:19] nt
  v_xor_b32 v18, 0x23000, v18
  v_mfma_f32_16x16x32_bf16 v[68:71], v[168:171], v[32:35], v[68:71]
  v_add_f32_dpp v80, v65, v64 row_ror:12 row_mask:0xf bank_mask:0xf
  s_nop 1
  v_add_f32_dpp v80, v66, v80 row_ror:8 row_mask:0xf bank_mask:0xf
  s_nop 1
  v_add_f32_dpp v85, v67, v80 row_ror:4 row_mask:0xf bank_mask:0x1
  s_cbranch_vccnz L_tf_333
  s_cbranch_scc1 L_tm_334
  s_waitcnt vmcnt(3)
L_tm_334:
  s_waitcnt vmcnt(4)
L_tf_333:
  s_cbranch_scc1 L_te_335
  s_waitcnt vmcnt(5)
L_te_335:
  s_waitcnt vmcnt(7)
  global_load_dwordx4 v[140:143], v18, s[18:19] nt
  v_xor_b32 v18, 0x2000, v18
  v_mfma_f32_16x16x32_bf16 v[72:75], v[172:175], v[28:31], 0
  v_and_b32 v254, 0xf0, v4
  v_xor_b32 v254, s45, v254
  v_bfe_i32 v7, v1, 4, 1
  v_and_b32 v7, 0x100, v7
  v_xor_b32 v254, v254, v7
  v_bfe_i32 v7, v1, 5, 1
  v_and_b32 v7, 0x200, v7
  v_xor_b32 v254, v254, v7
  v_mov_b32 v8, 1
  s_mov_b64 exec, 1
  ds_add_u32 v2, v8 offset:3120
  s_mov_b64 exec, -1
  s_memrealtime s[58:59]
  ds_read_b64 v[252:253], v2 offset:3112
  s_cmp_gt_i32 s57, 26
  s_cselect_b64 vcc, -1, 0
  s_cselect_b32 s33, s98, s99
  s_cmp_gt_i32 s57, s33
  s_cbranch_vccnz L_tf_336
  s_cbranch_scc1 L_tm_337
  s_waitcnt vmcnt(3)
L_tm_337:
  s_waitcnt vmcnt(4)
L_tf_336:
  s_cbranch_scc1 L_te_338
  s_waitcnt vmcnt(5)
L_te_338:
  s_waitcnt vmcnt(7)
  global_load_dwordx4 v[144:147], v18, s[18:19] nt
  v_xor_b32 v18, 0x3000, v18
  v_mfma_f32_16x16x32_bf16 v[72:75], v[176:179], v[32:35], v[72:75]
  v_add_f32_dpp v81, v70, v69 row_ror:12 row_mask:0xf bank_mask:0xf
  s_nop 1
  v_add_f32_dpp v81, v71, v81 row_ror:8 row_mask:0xf bank_mask:0xf
  s_nop 1
  v_add_f32_dpp v85, v68, v81 row_ror:4 row_mask:0xf bank_mask:0x2
  s_cbranch_vccnz L_tf_339
  s_cbranch_scc1 L_tm_340
  s_waitcnt vmcnt(3)
L_tm_340:
  s_waitcnt vmcnt(4)
L_tf_339:
  s_cbranch_scc1 L_te_341
  s_waitcnt vmcnt(5)
L_te_341:
  s_waitcnt vmcnt(7)
  global_load_dwordx4 v[148:151], v18, s[18:19] nt
  v_xor_b32 v18, 0x2000, v18
  v_mfma_f32_16x16x32_bf16 v[76:79], v[180:183], v[28:31], 0
  s_waitcnt lgkmcnt(0)
  v_readfirstlane_b32 s54, v252
  v_readfirstlane_b32 s59, v253
  s_sub_u32 s57, s58, s54
  s_mul_i32 s33, s59, 17
  s_lshr_b32 s33, s33, 4
  s_cselect_b32 s57, s57, 0
  s_sub_u32 s57, s57, s33
  s_cmp_gt_i32 s57, 26
  s_cselect_b64 vcc, -1, 0
  s_cselect_b32 s33, s98, s99
  s_cmp_gt_i32 s57, s33
  s_cbranch_vccnz L_tf_342
  s_cbranch_scc1 L_tm_343
  s_waitcnt vmcnt(3)
L_tm_343:
  s_waitcnt vmcnt(4)
L_tf_342:
  s_cbranch_scc1 L_te_344
  s_waitcnt vmcnt(5)
L_te_344:
  s_waitcnt vmcnt(7)
  global_load_dwordx4 v[152:155], v18, s[18:19] nt
  v_xor_b32 v18, 0xa3000, v18
  v_mfma_f32_16x16x32_bf16 v[76:79], v[184:187], v[32:35], v[76:79]
  v_add_f32_dpp v82, v75, v74 row_ror:12 row_mask:0xf bank_mask:0xf
  s_nop 1
  v_add_f32_dpp v82, v72, v82 row_ror:8 row_mask:0xf bank_mask:0xf
  s_nop 1
  v_add_f32_dpp v85, v73, v82 row_ror:4 row_mask:0xf bank_mask:0x4
  s_cbranch_vccnz L_tf_345
  s_cbranch_scc1 L_tm_346
  s_waitcnt vmcnt(3)
L_tm_346:
  s_waitcnt vmcnt(4)
L_tf_345:
  s_cbranch_scc1 L_te_347
  s_waitcnt vmcnt(5)
L_te_347:
  s_waitcnt vmcnt(7)
  global_load_dwordx4 v[156:159], v18, s[18:19] nt
  v_xor_b32 v18, 0x2000, v18
  v_add_f32_dpp v83, v76, v79 row_ror:12 row_mask:0xf bank_mask:0xf
  s_nop 1
  v_add_f32_dpp v83, v77, v83 row_ror:8 row_mask:0xf bank_mask:0xf
  s_nop 1
  v_add_f32_dpp v85, v78, v83 row_ror:4 row_mask:0xf bank_mask:0x8
  v_max_f32 v7, v84, v85
  s_nop 1
  v_max_f32_dpp v7, v7, v7 row_ror:2 row_mask:0xf bank_mask:0xf
  s_nop 1
  v_max_f32_dpp v7, v7, v7 row_ror:4 row_mask:0xf bank_mask:0xf
  s_nop 1
  v_max_f32_dpp v7, v7, v7 row_ror:8 row_mask:0xf bank_mask:0xf
  v_mov_b32 v8, v7
  s_nop 1
  v_permlane16_swap_b32 v7, v8
  v_max_f32 v7, v7, v8
  v_mov_b32 v8, v7
  s_nop 1
  v_permlane32_swap_b32 v7, v8
  v_max_f32 v7, v7, v8
  v_mul_f32 v11, s40, v7
  v_fma_f32 v84, v84, s40, -v11
  v_fma_f32 v85, v85, s40, -v11
  v_exp_f32 v84, v84
  v_exp_f32 v85, v85
  s_nop 0
  v_cvt_pk_bf16_f32 v13, v84, v85
  v_add_f32 v12, v85, v84
  s_cbranch_vccnz L_tf_348
  s_cbranch_scc1 L_tm_349
  s_waitcnt vmcnt(3)
L_tm_349:
  s_waitcnt vmcnt(4)
L_tf_348:
  s_cbranch_scc1 L_te_350
  s_waitcnt vmcnt(5)
L_te_350:
  s_waitcnt vmcnt(7)
  global_load_dwordx4 v[160:163], v18, s[18:19] nt
  v_xor_b32 v18, 0x3000, v18
  v_mov_b32_dpp v56, v13 row_newbcast:0 row_mask:0xf bank_mask:0x3
  v_mov_b32_dpp v57, v13 row_newbcast:2 row_mask:0xf bank_mask:0x3
  s_nop 0
  v_mov_b32_dpp v56, v13 row_newbcast:1 row_mask:0xf bank_mask:0xc
  v_mov_b32_dpp v57, v13 row_newbcast:3 row_mask:0xf bank_mask:0xc
  v_perm_b32 v92, v56, v56, v20
  v_perm_b32 v93, v56, v56, v21
  v_perm_b32 v94, v56, v56, v22
  v_perm_b32 v95, v56, v56, v23
  v_mov_b32_dpp v58, v13 row_newbcast:4 row_mask:0xf bank_mask:0x3
  v_perm_b32 v96, v57, v57, v20
  v_perm_b32 v97, v57, v57, v21
  v_mov_b32_dpp v58, v13 row_newbcast:5 row_mask:0xf bank_mask:0xc
  v_perm_b32 v98, v57, v57, v22
  v_perm_b32 v99, v57, v57, v23
  v_mov_b32_dpp v59, v13 row_newbcast:6 row_mask:0xf bank_mask:0x3
  v_perm_b32 v100, v58, v58, v20
  v_perm_b32 v101, v58, v58, v21
  v_mov_b32_dpp v59, v13 row_newbcast:7 row_mask:0xf bank_mask:0xc
  v_perm_b32 v102, v58, v58, v22
  v_perm_b32 v103, v58, v58, v23
  v_mov_b32_dpp v60, v13 row_newbcast:8 row_mask:0xf bank_mask:0x3
  v_perm_b32 v104, v59, v59, v20
  v_perm_b32 v105, v59, v59, v21
  v_mov_b32_dpp v60, v13 row_newbcast:9 row_mask:0xf bank_mask:0xc
  v_perm_b32 v106, v59, v59, v22
  v_perm_b32 v107, v59, v59, v23
  v_mov_b32_dpp v61, v13 row_newbcast:10 row_mask:0xf bank_mask:0x3
  v_perm_b32 v108, v60, v60, v20
  v_perm_b32 v109, v60, v60, v21
  v_mov_b32_dpp v61, v13 row_newbcast:11 row_mask:0xf bank_mask:0xc
  v_perm_b32 v110, v60, v60, v22
  v_perm_b32 v111, v60, v60, v23
  v_mov_b32_dpp v62, v13 row_newbcast:12 row_mask:0xf bank_mask:0x3
  v_perm_b32 v112, v61, v61, v20
  v_perm_b32 v113, v61, v61, v21
  v_mov_b32_dpp v62, v13 row_newbcast:13 row_mask:0xf bank_mask:0xc
  v_perm_b32 v114, v61, v61, v22
  v_perm_b32 v115, v61, v61, v23
  v_mov_b32_dpp v63, v13 row_newbcast:14 row_mask:0xf bank_mask:0x3
  v_perm_b32 v116, v62, v62, v20
  v_perm_b32 v117, v62, v62, v21
  v_mov_b32_dpp v63, v13 row_newbcast:15 row_mask:0xf bank_mask:0xc
  v_perm_b32 v118, v62, v62, v22
  v_perm_b32 v119, v62, v62, v23
  v_perm_b32 v120, v63, v63, v20
  v_perm_b32 v121, v63, v63, v21
  v_perm_b32 v122, v63, v63, v22
  v_perm_b32 v123, v63, v63, v23
  v_mfma_f32_16x16x32_bf16 v[40:43], v[92:95], v[124:127], 0
  v_mov_b32_dpp v56, v13 row_newbcast:0 row_mask:0xf bank_mask:0x3
  v_mov_b32_dpp v57, v13 row_newbcast:2 row_mask:0xf bank_mask:0x3
  s_nop 0
  v_mov_b32_dpp v56, v13 row_newbcast:1 row_mask:0xf bank_mask:0xc
  v_mov_b32_dpp v57, v13 row_newbcast:3 row_mask:0xf bank_mask:0xc
  v_perm_b32 v92, v56, v56, v24
  v_perm_b32 v93, v56, v56, v25
  v_perm_b32 v94, v56, v56, v26
  v_perm_b32 v95, v56, v56, v27
  v_mfma_f32_16x16x32_bf16 v[40:43], v[96:99], v[128:131], v[40:43]
  v_mov_b32_dpp v58, v13 row_newbcast:4 row_mask:0xf bank_mask:0x3
  v_perm_b32 v96, v57, v57, v24
  v_perm_b32 v97, v57, v57, v25
  v_mov_b32_dpp v58, v13 row_newbcast:5 row_mask:0xf bank_mask:0xc
  v_perm_b32 v98, v57, v57, v26
  v_perm_b32 v99, v57, v57, v27
  v_add_f32_dpp v12, v12, v12 row_ror:2 row_mask:0xf bank_mask:0xf
  s_nop 1
  v_add_f32_dpp v12, v12, v12 row_ror:4 row_mask:0xf bank_mask:0xf
  s_nop 1
  v_add_f32_dpp v12, v12, v12 row_ror:8 row_mask:0xf bank_mask:0xf
  v_mov_b32 v7, v12
  s_nop 1
  v_permlane16_swap_b32 v12, v7
  v_add_f32 v12, v12, v7
  v_mov_b32 v7, v12
  s_nop 1
  v_permlane32_swap_b32 v12, v7
  v_add_f32 v12, v12, v7
  v_mov_b32 v44, v9
  v_mov_b32 v45, v10
  v_mov_b32 v46, v11
  v_mov_b32 v47, v12
  s_lshl_b32 s34, s30, 5
  v_add_u32 v7, s34, v4
  s_mov_b64 exec, 3
  ds_write_b128 v7, v[44:47] offset:3392
  v_mov_b32 v8, 1
  s_mov_b64 exec, 1
  ds_add_u32 v2, v8 offset:3088
  s_mov_b64 exec, -1
  s_cmp_gt_i32 s57, 26
  s_cselect_b64 vcc, -1, 0
  s_cselect_b32 s33, s98, s99
  s_cmp_gt_i32 s57, s33
  s_cbranch_vccnz L_tf_351
  s_cbranch_scc1 L_tm_352
  s_waitcnt vmcnt(3)
L_tm_352:
  s_waitcnt vmcnt(4)
L_tf_351:
  s_cbranch_scc1 L_te_353
  s_waitcnt vmcnt(5)
L_te_353:
  s_waitcnt vmcnt(7)
  global_load_dwordx4 v[164:167], v18, s[18:19] nt
  v_xor_b32 v18, 0x2000, v18
  v_mfma_f32_16x16x32_bf16 v[40:43], v[100:103], v[132:135], v[40:43]
  v_mov_b32_dpp v59, v13 row_newbcast:6 row_mask:0xf bank_mask:0x3
  v_perm_b32 v100, v58, v58, v24
  v_perm_b32 v101, v58, v58, v25
  v_mov_b32_dpp v59, v13 row_newbcast:7 row_mask:0xf bank_mask:0xc
  v_perm_b32 v102, v58, v58, v26
  v_perm_b32 v103, v58, v58, v27
  s_cbranch_vccnz L_tf_354
  s_cbranch_scc1 L_tm_355
  s_waitcnt vmcnt(3)
L_tm_355:
  s_waitcnt vmcnt(4)
L_tf_354:
  s_cbranch_scc1 L_te_356
  s_waitcnt vmcnt(5)
L_te_356:
  s_waitcnt vmcnt(7)
  global_load_dwordx4 v[168:171], v18, s[18:19] nt
  v_xor_b32 v18, 0x23000, v18
  v_mfma_f32_16x16x32_bf16 v[40:43], v[104:107], v[136:139], v[40:43]
  v_mov_b32_dpp v60, v13 row_newbcast:8 row_mask:0xf bank_mask:0x3
  v_perm_b32 v104, v59, v59, v24
  v_perm_b32 v105, v59, v59, v25
  v_mov_b32_dpp v60, v13 row_newbcast:9 row_mask:0xf bank_mask:0xc
  v_perm_b32 v106, v59, v59, v26
  v_perm_b32 v107, v59, v59, v27
  s_cbranch_vccnz L_tf_357
  s_cbranch_scc1 L_tm_358
  s_waitcnt vmcnt(3)
L_tm_358:
  s_waitcnt vmcnt(4)
L_tf_357:
  s_cbranch_scc1 L_te_359
  s_waitcnt vmcnt(5)
L_te_359:
  s_waitcnt vmcnt(7)
  global_load_dwordx4 v[172:175], v18, s[18:19] nt
  v_xor_b32 v18, 0x2000, v18
  v_mfma_f32_16x16x32_bf16 v[40:43], v[108:111], v[140:143], v[40:43]
  v_mov_b32_dpp v61, v13 row_newbcast:10 row_mask:0xf bank_mask:0x3
  v_perm_b32 v108, v60, v60, v24
  v_perm_b32 v109, v60, v60, v25
  v_mov_b32_dpp v61, v13 row_newbcast:11 row_mask:0xf bank_mask:0xc
  v_perm_b32 v110, v60, v60, v26
  v_perm_b32 v111, v60, v60, v27
  s_memrealtime s[58:59]
  ds_read_b64 v[252:253], v2 offset:3112
  s_cbranch_vccnz L_tf_360
  s_cbranch_scc1 L_tm_361
  s_waitcnt vmcnt(3)
L_tm_361:
  s_waitcnt vmcnt(4)
L_tf_360:
  s_cbranch_scc1 L_te_362
  s_waitcnt vmcnt(5)
L_te_362:
  s_waitcnt vmcnt(7)
  global_load_dwordx4 v[176:179], v18, s[18:19] nt
  v_xor_b32 v18, 0x3000, v18
  v_mfma_f32_16x16x32_bf16 v[40:43], v[112:115], v[144:147], v[40:43]
  v_mov_b32_dpp v62, v13 row_newbcast:12 row_mask:0xf bank_mask:0x3
  v_perm_b32 v112, v61, v61, v24
  v_perm_b32 v113, v61, v61, v25
  v_mov_b32_dpp v62, v13 row_newbcast:13 row_mask:0xf bank_mask:0xc
  v_perm_b32 v114, v61, v61, v26
  v_perm_b32 v115, v61, v61, v27
  s_cbranch_vccnz L_tf_363
  s_cbranch_scc1 L_tm_364
  s_waitcnt vmcnt(3)
L_tm_364:
  s_waitcnt vmcnt(4)
L_tf_363:
  s_cbranch_scc1 L_te_365
  s_waitcnt vmcnt(5)
L_te_365:
  s_waitcnt vmcnt(7)
  global_load_dwordx4 v[180:183], v18, s[18:19] nt
  v_xor_b32 v18, 0x2000, v18
  v_mfma_f32_16x16x32_bf16 v[40:43], v[116:119], v[148:151], v[40:43]
  v_mov_b32_dpp v63, v13 row_newbcast:14 row_mask:0xf bank_mask:0x3
  v_perm_b32 v116, v62, v62, v24
  v_perm_b32 v117, v62, v62, v25
  v_mov_b32_dpp v63, v13 row_newbcast:15 row_mask:0xf bank_mask:0xc
  v_perm_b32 v118, v62, v62, v26
  v_perm_b32 v119, v62, v62, v27
  s_waitcnt lgkmcnt(0)
  v_readfirstlane_b32 s54, v252
  v_readfirstlane_b32 s59, v253
  s_sub_u32 s57, s58, s54
  s_mul_i32 s33, s59, 18
  s_lshr_b32 s33, s33, 4
  s_cselect_b32 s57, s57, 0
  s_sub_u32 s57, s57, s33
  s_cmp_gt_i32 s57, 26
  s_cselect_b64 vcc, -1, 0
  s_cselect_b32 s33, s98, s99
  s_cmp_gt_i32 s57, s33
  s_cbranch_vccnz L_tf_366
  s_cbranch_scc1 L_tm_367
  s_waitcnt vmcnt(3)
L_tm_367:
  s_waitcnt vmcnt(4)
L_tf_366:
  s_cbranch_scc1 L_te_368
  s_waitcnt vmcnt(5)
L_te_368:
  s_waitcnt vmcnt(7)
  global_load_dwordx4 v[184:187], v18, s[18:19] nt
  v_mov_b32 v18, v254
  v_mfma_f32_16x16x32_bf16 v[40:43], v[120:123], v[152:155], v[40:43]
  v_perm_b32 v120, v63, v63, v24
  v_perm_b32 v121, v63, v63, v25
  v_perm_b32 v122, v63, v63, v26
  v_perm_b32 v123, v63, v63, v27
  s_cbranch_vccnz L_tf_369
  s_cbranch_scc1 L_tm_370
  s_waitcnt vmcnt(3)
L_tm_370:
  s_waitcnt vmcnt(4)
L_tf_369:
  s_cbranch_scc1 L_te_371
  s_waitcnt vmcnt(5)
L_te_371:
  s_waitcnt vmcnt(7)
  global_load_dwordx4 v[124:127], v18, s[8:9] nt
  v_xor_b32 v18, 0x2000, v18
  v_mfma_f32_16x16x32_bf16 v[40:43], v[92:95], v[156:159], v[40:43]
  v_mov_b32_dpp v56, v48 row_newbcast:0 row_mask:0xf bank_mask:0x3
  v_mov_b32_dpp v57, v48 row_newbcast:2 row_mask:0xf bank_mask:0x3
  s_nop 0
  v_mov_b32_dpp v56, v48 row_newbcast:1 row_mask:0xf bank_mask:0xc
  v_mov_b32_dpp v57, v48 row_newbcast:3 row_mask:0xf bank_mask:0xc
  v_perm_b32 v92, v56, v56, v20
  v_perm_b32 v93, v56, v56, v21
  v_perm_b32 v94, v56, v56, v22
  v_perm_b32 v95, v56, v56, v23
  s_cbranch_vccnz L_tf_372
  s_cbranch_scc1 L_tm_373
  s_waitcnt vmcnt(3)
L_tm_373:
  s_waitcnt vmcnt(4)
L_tf_372:
  s_cbranch_scc1 L_te_374
  s_waitcnt vmcnt(5)
L_te_374:
  s_waitcnt vmcnt(7)
  global_load_dwordx4 v[128:131], v18, s[8:9] nt
  v_xor_b32 v18, 0x2400, v18
  v_mfma_f32_16x16x32_bf16 v[40:43], v[96:99], v[160:163], v[40:43]
  v_mov_b32_dpp v58, v48 row_newbcast:4 row_mask:0xf bank_mask:0x3
  v_perm_b32 v96, v57, v57, v20
  v_perm_b32 v97, v57, v57, v21
  v_mov_b32_dpp v58, v48 row_newbcast:5 row_mask:0xf bank_mask:0xc
  v_perm_b32 v98, v57, v57, v22
  v_perm_b32 v99, v57, v57, v23
  s_cbranch_vccnz L_tf_375
  s_cbranch_scc1 L_tm_376
  s_waitcnt vmcnt(3)
L_tm_376:
  s_waitcnt vmcnt(4)
L_tf_375:
  s_cbranch_scc1 L_te_377
  s_waitcnt vmcnt(5)
L_te_377:
  s_waitcnt vmcnt(7)
  global_load_dwordx4 v[132:135], v18, s[8:9] nt
  v_xor_b32 v18, 0x2000, v18
  v_mfma_f32_16x16x32_bf16 v[40:43], v[100:103], v[164:167], v[40:43]
  v_mov_b32_dpp v59, v48 row_newbcast:6 row_mask:0xf bank_mask:0x3
  v_perm_b32 v100, v58, v58, v20
  v_perm_b32 v101, v58, v58, v21
  v_mov_b32_dpp v59, v48 row_newbcast:7 row_mask:0xf bank_mask:0xc
  v_perm_b32 v102, v58, v58, v22
  v_perm_b32 v103, v58, v58, v23
  s_cbranch_vccnz L_tf_378
  s_cbranch_scc1 L_tm_379
  s_waitcnt vmcnt(3)
L_tm_379:
  s_waitcnt vmcnt(4)
L_tf_378:
  s_cbranch_scc1 L_te_380
  s_waitcnt vmcnt(5)
L_te_380:
  s_waitcnt vmcnt(7)
  global_load_dwordx4 v[136:139], v18, s[8:9] nt
  v_xor_b32 v18, 0x102400, v18
  v_mfma_f32_16x16x32_bf16 v[40:43], v[104:107], v[168:171], v[40:43]
  v_mov_b32_dpp v60, v48 row_newbcast:8 row_mask:0xf bank_mask:0x3
  v_perm_b32 v104, v59, v59, v20
  v_perm_b32 v105, v59, v59, v21
  v_mov_b32_dpp v60, v48 row_newbcast:9 row_mask:0xf bank_mask:0xc
  v_perm_b32 v106, v59, v59, v22
  v_perm_b32 v107, v59, v59, v23
  s_cbranch_vccnz L_tf_381
  s_cbranch_scc1 L_tm_382
  s_waitcnt vmcnt(3)
L_tm_382:
  s_waitcnt vmcnt(4)
L_tf_381:
  s_cbranch_scc1 L_te_383
  s_waitcnt vmcnt(5)
L_te_383:
  s_waitcnt vmcnt(7)
  global_load_dwordx4 v[140:143], v18, s[8:9] nt
  v_xor_b32 v18, 0x2000, v18
  v_mfma_f32_16x16x32_bf16 v[40:43], v[108:111], v[172:175], v[40:43]
  v_mov_b32_dpp v61, v48 row_newbcast:10 row_mask:0xf bank_mask:0x3
  v_perm_b32 v108, v60, v60, v20
  v_perm_b32 v109, v60, v60, v21
  v_mov_b32_dpp v61, v48 row_newbcast:11 row_mask:0xf bank_mask:0xc
  v_perm_b32 v110, v60, v60, v22
  v_perm_b32 v111, v60, v60, v23
  s_memrealtime s[58:59]
  ds_read_b64 v[252:253], v2 offset:3112
  s_cbranch_vccnz L_tf_384
  s_cbranch_scc1 L_tm_385
  s_waitcnt vmcnt(3)
L_tm_385:
  s_waitcnt vmcnt(4)
L_tf_384:
  s_cbranch_scc1 L_te_386
  s_waitcnt vmcnt(5)
L_te_386:
  s_waitcnt vmcnt(7)
  global_load_dwordx4 v[144:147], v18, s[8:9] nt
  v_xor_b32 v18, 0x2400, v18
  v_mfma_f32_16x16x32_bf16 v[40:43], v[112:115], v[176:179], v[40:43]
  v_mov_b32_dpp v62, v48 row_newbcast:12 row_mask:0xf bank_mask:0x3
  v_perm_b32 v112, v61, v61, v20
  v_perm_b32 v113, v61, v61, v21
  v_mov_b32_dpp v62, v48 row_newbcast:13 row_mask:0xf bank_mask:0xc
  v_perm_b32 v114, v61, v61, v22
  v_perm_b32 v115, v61, v61, v23
  s_cbranch_vccnz L_tf_387
  s_cbranch_scc1 L_tm_388
  s_waitcnt vmcnt(3)
L_tm_388:
  s_waitcnt vmcnt(4)
L_tf_387:
  s_cbranch_scc1 L_te_389
  s_waitcnt vmcnt(5)
L_te_389:
  s_waitcnt vmcnt(7)
  global_load_dwordx4 v[148:151], v18, s[8:9] nt
  v_xor_b32 v18, 0x2000, v18
  v_mfma_f32_16x16x32_bf16 v[40:43], v[116:119], v[180:183], v[40:43]
  v_mov_b32_dpp v63, v48 row_newbcast:14 row_mask:0xf bank_mask:0x3
  v_perm_b32 v116, v62, v62, v20
  v_perm_b32 v117, v62, v62, v21
  v_mov_b32_dpp v63, v48 row_newbcast:15 row_mask:0xf bank_mask:0xc
  v_perm_b32 v118, v62, v62, v22
  v_perm_b32 v119, v62, v62, v23
  s_waitcnt lgkmcnt(0)
  v_readfirstlane_b32 s54, v252
  v_readfirstlane_b32 s59, v253
  s_sub_u32 s57, s58, s54
  s_mul_i32 s33, s59, 19
  s_lshr_b32 s33, s33, 4
  s_cselect_b32 s57, s57, 0
  s_sub_u32 s57, s57, s33
  s_cmp_gt_i32 s57, 26
  s_cselect_b64 vcc, -1, 0
  s_cselect_b32 s33, s98, s99
  s_cmp_gt_i32 s57, s33
  s_cbranch_vccnz L_tf_390
  s_cbranch_scc1 L_tm_391
  s_waitcnt vmcnt(3)
L_tm_391:
  s_waitcnt vmcnt(4)
L_tf_390:
  s_cbranch_scc1 L_te_392
  s_waitcnt vmcnt(5)
L_te_392:
  s_waitcnt vmcnt(7)
  global_load_dwordx4 v[152:155], v18, s[8:9] nt
  v_xor_b32 v18, 0x112400, v18
  v_mfma_f32_16x16x32_bf16 v[40:43], v[120:123], v[184:187], v[40:43]
  v_perm_b32 v120, v63, v63, v20
  v_perm_b32 v121, v63, v63, v21
  v_perm_b32 v122, v63, v63, v22
  v_perm_b32 v123, v63, v63, v23
  s_cbranch_vccnz L_tf_393
  s_cbranch_scc1 L_tm_394
  s_waitcnt vmcnt(3)
L_tm_394:
  s_waitcnt vmcnt(4)
L_tf_393:
  s_cbranch_scc1 L_te_395
  s_waitcnt vmcnt(5)
L_te_395:
  s_waitcnt vmcnt(7)
  global_load_dwordx4 v[156:159], v18, s[8:9] nt
  v_xor_b32 v18, 0x2000, v18
  v_mfma_f32_16x16x32_bf16 v[36:39], v[92:95], v[124:127], 0
  v_mov_b32_dpp v56, v48 row_newbcast:0 row_mask:0xf bank_mask:0x3
  v_mov_b32_dpp v57, v48 row_newbcast:2 row_mask:0xf bank_mask:0x3
  s_nop 0
  v_mov_b32_dpp v56, v48 row_newbcast:1 row_mask:0xf bank_mask:0xc
  v_mov_b32_dpp v57, v48 row_newbcast:3 row_mask:0xf bank_mask:0xc
  v_perm_b32 v92, v56, v56, v24
  v_perm_b32 v93, v56, v56, v25
  v_perm_b32 v94, v56, v56, v26
  v_perm_b32 v95, v56, v56, v27
  s_cbranch_vccnz L_tf_396
  s_cbranch_scc1 L_tm_397
  s_waitcnt vmcnt(3)
L_tm_397:
  s_waitcnt vmcnt(4)
L_tf_396:
  s_cbranch_scc1 L_te_398
  s_waitcnt vmcnt(5)
L_te_398:
  s_waitcnt vmcnt(7)
  global_load_dwordx4 v[160:163], v18, s[8:9] nt
  v_xor_b32 v18, 0x2400, v18
  v_mfma_f32_16x16x32_bf16 v[36:39], v[96:99], v[128:131], v[36:39]
  v_mov_b32_dpp v58, v48 row_newbcast:4 row_mask:0xf bank_mask:0x3
  v_perm_b32 v96, v57, v57, v24
  v_perm_b32 v97, v57, v57, v25
  v_mov_b32_dpp v58, v48 row_newbcast:5 row_mask:0xf bank_mask:0xc
  v_perm_b32 v98, v57, v57, v26
  v_perm_b32 v99, v57, v57, v27
  s_cbranch_vccnz L_tf_399
  s_cbranch_scc1 L_tm_400
  s_waitcnt vmcnt(3)
L_tm_400:
  s_waitcnt vmcnt(4)
L_tf_399:
  s_cbranch_scc1 L_te_401
  s_waitcnt vmcnt(5)
L_te_401:
  s_waitcnt vmcnt(7)
  global_load_dwordx4 v[164:167], v18, s[8:9] nt
  v_xor_b32 v18, 0x2000, v18
  v_mfma_f32_16x16x32_bf16 v[36:39], v[100:103], v[132:135], v[36:39]
  v_mov_b32_dpp v59, v48 row_newbcast:6 row_mask:0xf bank_mask:0x3
  v_perm_b32 v100, v58, v58, v24
  v_perm_b32 v101, v58, v58, v25
  v_mov_b32_dpp v59, v48 row_newbcast:7 row_mask:0xf bank_mask:0xc
  v_perm_b32 v102, v58, v58, v26
  v_perm_b32 v103, v58, v58, v27
  s_cbranch_vccnz L_tf_402
  s_cbranch_scc1 L_tm_403
  s_waitcnt vmcnt(3)
L_tm_403:
  s_waitcnt vmcnt(4)
L_tf_402:
  s_cbranch_scc1 L_te_404
  s_waitcnt vmcnt(5)
L_te_404:
  s_waitcnt vmcnt(7)
  global_load_dwordx4 v[168:171], v18, s[8:9] nt
  v_xor_b32 v18, 0x102400, v18
  v_mfma_f32_16x16x32_bf16 v[36:39], v[104:107], v[136:139], v[36:39]
  v_mov_b32_dpp v60, v48 row_newbcast:8 row_mask:0xf bank_mask:0x3
  v_perm_b32 v104, v59, v59, v24
  v_perm_b32 v105, v59, v59, v25
  v_mov_b32_dpp v60, v48 row_newbcast:9 row_mask:0xf bank_mask:0xc
  v_perm_b32 v106, v59, v59, v26
  v_perm_b32 v107, v59, v59, v27
  s_cbranch_vccnz L_tf_405
  s_cbranch_scc1 L_tm_406
  s_waitcnt vmcnt(3)
L_tm_406:
  s_waitcnt vmcnt(4)
L_tf_405:
  s_cbranch_scc1 L_te_407
  s_waitcnt vmcnt(5)
L_te_407:
  s_waitcnt vmcnt(7)
  global_load_dwordx4 v[172:175], v18, s[8:9] nt
  v_xor_b32 v18, 0x2000, v18
  v_mfma_f32_16x16x32_bf16 v[36:39], v[108:111], v[140:143], v[36:39]
  v_mov_b32_dpp v61, v48 row_newbcast:10 row_mask:0xf bank_mask:0x3
  v_perm_b32 v108, v60, v60, v24
  v_perm_b32 v109, v60, v60, v25
  v_mov_b32_dpp v61, v48 row_newbcast:11 row_mask:0xf bank_mask:0xc
  v_perm_b32 v110, v60, v60, v26
  v_perm_b32 v111, v60, v60, v27
  s_memrealtime s[58:59]
  ds_read_b64 v[252:253], v2 offset:3112
  s_cbranch_vccnz L_tf_408
  s_cbranch_scc1 L_tm_409
  s_waitcnt vmcnt(3)
L_tm_409:
  s_waitcnt vmcnt(4)
L_tf_408:
  s_cbranch_scc1 L_te_410
  s_waitcnt vmcnt(5)
L_te_410:
  s_waitcnt vmcnt(7)
  global_load_dwordx4 v[176:179], v18, s[8:9] nt
  v_xor_b32 v18, 0x2400, v18
  v_mfma_f32_16x16x32_bf16 v[36:39], v[112:115], v[144:147], v[36:39]
  v_mov_b32_dpp v62, v48 row_newbcast:12 row_mask:0xf bank_mask:0x3
  v_perm_b32 v112, v61, v61, v24
  v_perm_b32 v113, v61, v61, v25
  v_mov_b32_dpp v62, v48 row_newbcast:13 row_mask:0xf bank_mask:0xc
  v_perm_b32 v114, v61, v61, v26
  v_perm_b32 v115, v61, v61, v27
  s_cbranch_vccnz L_tf_411
  s_cbranch_scc1 L_tm_412
  s_waitcnt vmcnt(3)
L_tm_412:
  s_waitcnt vmcnt(4)
L_tf_411:
  s_cbranch_scc1 L_te_413
  s_waitcnt vmcnt(5)
L_te_413:
  s_waitcnt vmcnt(7)
  global_load_dwordx4 v[180:183], v18, s[8:9] nt
  v_xor_b32 v18, 0x2000, v18
  v_mfma_f32_16x16x32_bf16 v[36:39], v[116:119], v[148:151], v[36:39]
  v_mov_b32_dpp v63, v48 row_newbcast:14 row_mask:0xf bank_mask:0x3
  v_perm_b32 v116, v62, v62, v24
  v_perm_b32 v117, v62, v62, v25
  v_mov_b32_dpp v63, v48 row_newbcast:15 row_mask:0xf bank_mask:0xc
  v_perm_b32 v118, v62, v62, v26
  v_perm_b32 v119, v62, v62, v27
  s_waitcnt lgkmcnt(0)
  v_readfirstlane_b32 s54, v252
  v_readfirstlane_b32 s59, v253
  s_sub_u32 s57, s58, s54
  s_mul_i32 s33, s59, 20
  s_lshr_b32 s33, s33, 4
  s_cselect_b32 s57, s57, 0
  s_sub_u32 s57, s57, s33
  s_cmp_gt_i32 s57, 26
  s_cselect_b64 vcc, -1, 0
  s_cselect_b32 s33, s98, s99
  s_cmp_gt_i32 s57, s33
  s_cbranch_vccnz L_tf_414
  s_cbranch_scc1 L_tm_415
  s_waitcnt vmcnt(3)
L_tm_415:
  s_waitcnt vmcnt(4)
L_tf_414:
  s_cbranch_scc1 L_te_416
  s_waitcnt vmcnt(5)
L_te_416:
  s_waitcnt vmcnt(7)
  global_load_dwordx4 v[184:187], v18, s[8:9] nt
  v_xor_b32 v18, 0x192400, v18
  v_mfma_f32_16x16x32_bf16 v[36:39], v[120:123], v[152:155], v[36:39]
  v_perm_b32 v120, v63, v63, v24
  v_perm_b32 v121, v63, v63, v25
  v_perm_b32 v122, v63, v63, v26
  v_perm_b32 v123, v63, v63, v27
  s_cbranch_vccnz L_tf_417
  s_cbranch_scc1 L_tm_418
  s_waitcnt vmcnt(3)
L_tm_418:
  s_waitcnt vmcnt(4)
L_tf_417:
  s_cbranch_scc1 L_te_419
  s_waitcnt vmcnt(5)
L_te_419:
  s_waitcnt vmcnt(7)
  global_load_dwordx4 v[124:127], v18, s[8:9] nt
  v_xor_b32 v18, 0x2000, v18
  v_mfma_f32_16x16x32_bf16 v[36:39], v[92:95], v[156:159], v[36:39]
  v_mov_b32_dpp v56, v49 row_newbcast:0 row_mask:0xf bank_mask:0x3
  v_mov_b32_dpp v57, v49 row_newbcast:2 row_mask:0xf bank_mask:0x3
  s_nop 0
  v_mov_b32_dpp v56, v49 row_newbcast:1 row_mask:0xf bank_mask:0xc
  v_mov_b32_dpp v57, v49 row_newbcast:3 row_mask:0xf bank_mask:0xc
  v_perm_b32 v92, v56, v56, v20
  v_perm_b32 v93, v56, v56, v21
  v_perm_b32 v94, v56, v56, v22
  v_perm_b32 v95, v56, v56, v23
  s_cbranch_vccnz L_tf_420
  s_cbranch_scc1 L_tm_421
  s_waitcnt vmcnt(3)
L_tm_421:
  s_waitcnt vmcnt(4)
L_tf_420:
  s_cbranch_scc1 L_te_422
  s_waitcnt vmcnt(5)
L_te_422:
  s_waitcnt vmcnt(7)
  global_load_dwordx4 v[128:131], v18, s[8:9] nt
  v_xor_b32 v18, 0x2400, v18
  v_mfma_f32_16x16x32_bf16 v[36:39], v[96:99], v[160:163], v[36:39]
  v_mov_b32_dpp v58, v49 row_newbcast:4 row_mask:0xf bank_mask:0x3
  v_perm_b32 v96, v57, v57, v20
  v_perm_b32 v97, v57, v57, v21
  v_mov_b32_dpp v58, v49 row_newbcast:5 row_mask:0xf bank_mask:0xc
  v_perm_b32 v98, v57, v57, v22
  v_perm_b32 v99, v57, v57, v23
  s_cbranch_vccnz L_tf_423
  s_cbranch_scc1 L_tm_424
  s_waitcnt vmcnt(3)
L_tm_424:
  s_waitcnt vmcnt(4)
L_tf_423:
  s_cbranch_scc1 L_te_425
  s_waitcnt vmcnt(5)
L_te_425:
  s_waitcnt vmcnt(7)
  global_load_dwordx4 v[132:135], v18, s[8:9] nt
  v_xor_b32 v18, 0x2000, v18
  v_mfma_f32_16x16x32_bf16 v[36:39], v[100:103], v[164:167], v[36:39]
  v_mov_b32_dpp v59, v49 row_newbcast:6 row_mask:0xf bank_mask:0x3
  v_perm_b32 v100, v58, v58, v20
  v_perm_b32 v101, v58, v58, v21
  v_mov_b32_dpp v59, v49 row_newbcast:7 row_mask:0xf bank_mask:0xc
  v_perm_b32 v102, v58, v58, v22
  v_perm_b32 v103, v58, v58, v23
  s_cbranch_vccnz L_tf_426
  s_cbranch_scc1 L_tm_427
  s_waitcnt vmcnt(3)
L_tm_427:
  s_waitcnt vmcnt(4)
L_tf_426:
  s_cbranch_scc1 L_te_428
  s_waitcnt vmcnt(5)
L_te_428:
  s_waitcnt vmcnt(7)
  global_load_dwordx4 v[136:139], v18, s[8:9] nt
  v_xor_b32 v18, 0x102400, v18
  v_mfma_f32_16x16x32_bf16 v[36:39], v[104:107], v[168:171], v[36:39]
  v_mov_b32_dpp v60, v49 row_newbcast:8 row_mask:0xf bank_mask:0x3
  v_perm_b32 v104, v59, v59, v20
  v_perm_b32 v105, v59, v59, v21
  v_mov_b32_dpp v60, v49 row_newbcast:9 row_mask:0xf bank_mask:0xc
  v_perm_b32 v106, v59, v59, v22
  v_perm_b32 v107, v59, v59, v23
  s_cbranch_vccnz L_tf_429
  s_cbranch_scc1 L_tm_430
  s_waitcnt vmcnt(3)
L_tm_430:
  s_waitcnt vmcnt(4)
L_tf_429:
  s_cbranch_scc1 L_te_431
  s_waitcnt vmcnt(5)
L_te_431:
  s_waitcnt vmcnt(7)
  global_load_dwordx4 v[140:143], v18, s[8:9] nt
  v_xor_b32 v18, 0x2000, v18
  v_mfma_f32_16x16x32_bf16 v[36:39], v[108:111], v[172:175], v[36:39]
  v_mov_b32_dpp v61, v49 row_newbcast:10 row_mask:0xf bank_mask:0x3
  v_perm_b32 v108, v60, v60, v20
  v_perm_b32 v109, v60, v60, v21
  v_mov_b32_dpp v61, v49 row_newbcast:11 row_mask:0xf bank_mask:0xc
  v_perm_b32 v110, v60, v60, v22
  v_perm_b32 v111, v60, v60, v23
  s_memrealtime s[58:59]
  ds_read_b64 v[252:253], v2 offset:3112
  s_cbranch_vccnz L_tf_432
  s_cbranch_scc1 L_tm_433
  s_waitcnt vmcnt(3)
L_tm_433:
  s_waitcnt vmcnt(4)
L_tf_432:
  s_cbranch_scc1 L_te_434
  s_waitcnt vmcnt(5)
L_te_434:
  s_waitcnt vmcnt(7)
  global_load_dwordx4 v[144:147], v18, s[8:9] nt
  v_xor_b32 v18, 0x2400, v18
  v_mfma_f32_16x16x32_bf16 v[36:39], v[112:115], v[176:179], v[36:39]
  v_mov_b32_dpp v62, v49 row_newbcast:12 row_mask:0xf bank_mask:0x3
  v_perm_b32 v112, v61, v61, v20
  v_perm_b32 v113, v61, v61, v21
  v_mov_b32_dpp v62, v49 row_newbcast:13 row_mask:0xf bank_mask:0xc
  v_perm_b32 v114, v61, v61, v22
  v_perm_b32 v115, v61, v61, v23
  s_cbranch_vccnz L_tf_435
  s_cbranch_scc1 L_tm_436
  s_waitcnt vmcnt(3)
L_tm_436:
  s_waitcnt vmcnt(4)
L_tf_435:
  s_cbranch_scc1 L_te_437
  s_waitcnt vmcnt(5)
L_te_437:
  s_waitcnt vmcnt(7)
  global_load_dwordx4 v[148:151], v18, s[8:9] nt
  v_xor_b32 v18, 0x2000, v18
  v_mfma_f32_16x16x32_bf16 v[36:39], v[116:119], v[180:183], v[36:39]
  v_mov_b32_dpp v63, v49 row_newbcast:14 row_mask:0xf bank_mask:0x3
  v_perm_b32 v116, v62, v62, v20
  v_perm_b32 v117, v62, v62, v21
  v_mov_b32_dpp v63, v49 row_newbcast:15 row_mask:0xf bank_mask:0xc
  v_perm_b32 v118, v62, v62, v22
  v_perm_b32 v119, v62, v62, v23
  s_waitcnt lgkmcnt(0)
  v_readfirstlane_b32 s54, v252
  v_readfirstlane_b32 s59, v253
  s_sub_u32 s57, s58, s54
  s_mul_i32 s33, s59, 21
  s_lshr_b32 s33, s33, 4
  s_cselect_b32 s57, s57, 0
  s_sub_u32 s57, s57, s33
  s_cmp_lg_u32 s55, 0
  s_cbranch_scc1 L_opt_438
  s_add_u32 s58, s58, s62
  s_lshl_b32 s33, s3, 8
  s_add_u32 s33, s33, 160512
  v_mov_b32 v7, s33
  v_mov_b32 v8, s58
  s_mov_b64 exec, 1
  global_store_dword v7, v8, s[28:29] sc1
  s_mov_b64 exec, -1
  s_nop 1
L_opt_438:
  s_cmp_gt_i32 s57, 26
  s_cselect_b64 vcc, -1, 0
  s_cselect_b32 s33, s98, s99
  s_cmp_gt_i32 s57, s33
  s_cbranch_vccnz L_tf_439
  s_cbranch_scc1 L_tm_440
  s_waitcnt vmcnt(3)
L_tm_440:
  s_waitcnt vmcnt(4)
L_tf_439:
  s_cbranch_scc1 L_te_441
  s_waitcnt vmcnt(5)
L_te_441:
  s_waitcnt vmcnt(7)
  global_load_dwordx4 v[152:155], v18, s[8:9] nt
  v_xor_b32 v18, 0x112400, v18
  v_mfma_f32_16x16x32_bf16 v[36:39], v[120:123], v[184:187], v[36:39]
  v_perm_b32 v120, v63, v63, v20
  v_perm_b32 v121, v63, v63, v21
  v_perm_b32 v122, v63, v63, v22
  v_perm_b32 v123, v63, v63, v23
  s_cbranch_vccnz L_tf_442
  s_cbranch_scc1 L_tm_443
  s_waitcnt vmcnt(3)
L_tm_443:
  s_waitcnt vmcnt(4)
L_tf_442:
  s_cbranch_scc1 L_te_444
  s_waitcnt vmcnt(5)
L_te_444:
  s_waitcnt vmcnt(7)
  global_load_dwordx4 v[156:159], v18, s[8:9] nt
  v_xor_b32 v18, 0x2000, v18
  v_mfma_f32_16x16x32_bf16 v[36:39], v[92:95], v[124:127], v[36:39]
  v_mov_b32_dpp v56, v49 row_newbcast:0 row_mask:0xf bank_mask:0x3
  v_mov_b32_dpp v57, v49 row_newbcast:2 row_mask:0xf bank_mask:0x3
  s_nop 0
  v_mov_b32_dpp v56, v49 row_newbcast:1 row_mask:0xf bank_mask:0xc
  v_mov_b32_dpp v57, v49 row_newbcast:3 row_mask:0xf bank_mask:0xc
  v_perm_b32 v92, v56, v56, v24
  v_perm_b32 v93, v56, v56, v25
  v_perm_b32 v94, v56, v56, v26
  v_perm_b32 v95, v56, v56, v27
  s_cbranch_vccnz L_tf_445
  s_cbranch_scc1 L_tm_446
  s_waitcnt vmcnt(3)
L_tm_446:
  s_waitcnt vmcnt(4)
L_tf_445:
  s_cbranch_scc1 L_te_447
  s_waitcnt vmcnt(5)
L_te_447:
  s_waitcnt vmcnt(7)
  global_load_dwordx4 v[160:163], v18, s[8:9] nt
  v_xor_b32 v18, 0x2400, v18
  v_mfma_f32_16x16x32_bf16 v[36:39], v[96:99], v[128:131], v[36:39]
  v_mov_b32_dpp v58, v49 row_newbcast:4 row_mask:0xf bank_mask:0x3
  v_perm_b32 v96, v57, v57, v24
  v_perm_b32 v97, v57, v57, v25
  v_mov_b32_dpp v58, v49 row_newbcast:5 row_mask:0xf bank_mask:0xc
  v_perm_b32 v98, v57, v57, v26
  v_perm_b32 v99, v57, v57, v27
  s_cbranch_vccnz L_tf_448
  s_cbranch_scc1 L_tm_449
  s_waitcnt vmcnt(3)
L_tm_449:
  s_waitcnt vmcnt(4)
L_tf_448:
  s_cbranch_scc1 L_te_450
  s_waitcnt vmcnt(5)
L_te_450:
  s_waitcnt vmcnt(7)
  global_load_dwordx4 v[164:167], v18, s[8:9] nt
  v_xor_b32 v18, 0x2000, v18
  v_mfma_f32_16x16x32_bf16 v[36:39], v[100:103], v[132:135], v[36:39]
  v_mov_b32_dpp v59, v49 row_newbcast:6 row_mask:0xf bank_mask:0x3
  v_perm_b32 v100, v58, v58, v24
  v_perm_b32 v101, v58, v58, v25
  v_mov_b32_dpp v59, v49 row_newbcast:7 row_mask:0xf bank_mask:0xc
  v_perm_b32 v102, v58, v58, v26
  v_perm_b32 v103, v58, v58, v27
  v_lshrrev_b32 v7, 3, v1
  v_mul_u32_u24 v7, 4608, v7
  v_and_b32 v8, 7, v1
  v_lshl_add_u32 v19, v8, 4, v7
  s_lshl_b32 s34, s31, 3
  s_and_b32 s35, s32, 7
  s_add_u32 s56, s34, s35
  s_mul_i32 s34, s56, 36864
  s_min_u32 s35, s30, 2
  s_mul_i32 s35, s35, 384
  s_add_u32 s34, s34, s35
  s_add_u32 s10, s10, s34
  s_addc_u32 s11, s11, 0
  s_cmp_lt_u32 s30, 3
  s_cselect_b64 s[50:51], -1, 1
  s_cmp_gt_i32 s57, 26
  s_cselect_b64 vcc, -1, 0
  s_cselect_b32 s33, s98, s99
  s_cmp_gt_i32 s57, s33
  s_cbranch_vccnz L_tf_451
  s_cbranch_scc1 L_tm_452
  s_waitcnt vmcnt(3)
L_tm_452:
  s_waitcnt vmcnt(4)
L_tf_451:
  s_cbranch_scc1 L_te_453
  s_waitcnt vmcnt(5)
L_te_453:
  s_waitcnt vmcnt(7)
  global_load_dwordx4 v[168:171], v18, s[8:9] nt
  v_xor_b32 v18, 0x102400, v18
  v_mfma_f32_16x16x32_bf16 v[36:39], v[104:107], v[136:139], v[36:39]
  v_mov_b32_dpp v60, v49 row_newbcast:8 row_mask:0xf bank_mask:0x3
  v_perm_b32 v104, v59, v59, v24
  v_perm_b32 v105, v59, v59, v25
  v_mov_b32_dpp v60, v49 row_newbcast:9 row_mask:0xf bank_mask:0xc
  v_perm_b32 v106, v59, v59, v26
  v_perm_b32 v107, v59, v59, v27
  s_cbranch_vccnz L_tf_454
  s_cbranch_scc1 L_tm_455
  s_waitcnt vmcnt(3)
L_tm_455:
  s_waitcnt vmcnt(4)
L_tf_454:
  s_cbranch_scc1 L_te_456
  s_waitcnt vmcnt(5)
L_te_456:
  s_waitcnt vmcnt(7)
  global_load_dwordx4 v[172:175], v18, s[8:9] nt
  v_xor_b32 v18, 0x2000, v18
  v_mfma_f32_16x16x32_bf16 v[36:39], v[108:111], v[140:143], v[36:39]
  v_mov_b32_dpp v61, v49 row_newbcast:10 row_mask:0xf bank_mask:0x3
  v_perm_b32 v108, v60, v60, v24
  v_perm_b32 v109, v60, v60, v25
  v_mov_b32_dpp v61, v49 row_newbcast:11 row_mask:0xf bank_mask:0xc
  v_perm_b32 v110, v60, v60, v26
  v_perm_b32 v111, v60, v60, v27
  s_memrealtime s[58:59]
  ds_read_b64 v[252:253], v2 offset:3112
  s_cbranch_vccnz L_tf_457
  s_cbranch_scc1 L_tm_458
  s_waitcnt vmcnt(3)
L_tm_458:
  s_waitcnt vmcnt(4)
L_tf_457:
  s_cbranch_scc1 L_te_459
  s_waitcnt vmcnt(5)
L_te_459:
  s_waitcnt vmcnt(7)
  global_load_dwordx4 v[176:179], v18, s[8:9] nt
  v_xor_b32 v18, 0x2400, v18
  v_mfma_f32_16x16x32_bf16 v[36:39], v[112:115], v[144:147], v[36:39]
  v_mov_b32_dpp v62, v49 row_newbcast:12 row_mask:0xf bank_mask:0x3
  v_perm_b32 v112, v61, v61, v24
  v_perm_b32 v113, v61, v61, v25
  v_mov_b32_dpp v62, v49 row_newbcast:13 row_mask:0xf bank_mask:0xc
  v_perm_b32 v114, v61, v61, v26
  v_perm_b32 v115, v61, v61, v27
  s_cbranch_vccnz L_tf_460
  s_cbranch_scc1 L_tm_461
  s_waitcnt vmcnt(3)
L_tm_461:
  s_waitcnt vmcnt(4)
L_tf_460:
  s_cbranch_scc1 L_te_462
  s_waitcnt vmcnt(5)
L_te_462:
  s_waitcnt vmcnt(7)
  global_load_dwordx4 v[180:183], v18, s[8:9] nt
  v_xor_b32 v18, 0x2000, v18
  v_mfma_f32_16x16x32_bf16 v[36:39], v[116:119], v[148:151], v[36:39]
  v_mov_b32_dpp v63, v49 row_newbcast:14 row_mask:0xf bank_mask:0x3
  v_perm_b32 v116, v62, v62, v24
  v_perm_b32 v117, v62, v62, v25
  v_mov_b32_dpp v63, v49 row_newbcast:15 row_mask:0xf bank_mask:0xc
  v_perm_b32 v118, v62, v62, v26
  v_perm_b32 v119, v62, v62, v27
  s_waitcnt lgkmcnt(0)
  v_readfirstlane_b32 s54, v252
  v_readfirstlane_b32 s59, v253
  s_sub_u32 s57, s58, s54
  s_mul_i32 s33, s59, 22
  s_lshr_b32 s33, s33, 4
  s_cselect_b32 s57, s57, 0
  s_sub_u32 s57, s57, s33
  s_cmp_gt_i32 s57, 26
  s_cselect_b64 vcc, -1, 0
  s_cselect_b32 s33, s98, s99
  s_cmp_gt_i32 s57, s33
  s_cbranch_vccnz L_tf_463
  s_cbranch_scc1 L_tm_464
  s_waitcnt vmcnt(3)
L_tm_464:
  s_waitcnt vmcnt(4)
L_tf_463:
  s_cbranch_scc1 L_te_465
  s_waitcnt vmcnt(5)
L_te_465:
  s_waitcnt vmcnt(7)
  global_load_dwordx4 v[184:187], v18, s[8:9] nt
  v_xor_b32 v18, 0x196400, v18
  v_mfma_f32_16x16x32_bf16 v[36:39], v[120:123], v[152:155], v[36:39]
  v_perm_b32 v120, v63, v63, v24
  v_perm_b32 v121, v63, v63, v25
  v_perm_b32 v122, v63, v63, v26
  v_perm_b32 v123, v63, v63, v27
  s_cbranch_vccnz L_tf_466
  s_cbranch_scc1 L_tm_467
  s_waitcnt vmcnt(3)
L_tm_467:
  s_waitcnt vmcnt(4)
L_tf_466:
  s_cbranch_scc1 L_te_468
  s_waitcnt vmcnt(5)
L_te_468:
  s_waitcnt vmcnt(7)
  global_load_dwordx4 v[124:127], v18, s[8:9] nt
  v_xor_b32 v18, 0x2000, v18
  v_mfma_f32_16x16x32_bf16 v[36:39], v[92:95], v[156:159], v[36:39]
  v_mov_b32_dpp v56, v50 row_newbcast:0 row_mask:0xf bank_mask:0x3
  v_mov_b32_dpp v57, v50 row_newbcast:2 row_mask:0xf bank_mask:0x3
  s_nop 0
  v_mov_b32_dpp v56, v50 row_newbcast:1 row_mask:0xf bank_mask:0xc
  v_mov_b32_dpp v57, v50 row_newbcast:3 row_mask:0xf bank_mask:0xc
  v_perm_b32 v92, v56, v56, v20
  v_perm_b32 v93, v56, v56, v21
  v_perm_b32 v94, v56, v56, v22
  v_perm_b32 v95, v56, v56, v23
  s_cbranch_vccnz L_tf_469
  s_cbranch_scc1 L_tm_470
  s_waitcnt vmcnt(3)
L_tm_470:
  s_waitcnt vmcnt(4)
L_tf_469:
  s_cbranch_scc1 L_te_471
  s_waitcnt vmcnt(5)
L_te_471:
  s_waitcnt vmcnt(7)
  global_load_dwordx4 v[128:131], v18, s[8:9] nt
  v_xor_b32 v18, 0x2400, v18
  v_mfma_f32_16x16x32_bf16 v[36:39], v[96:99], v[160:163], v[36:39]
  v_mov_b32_dpp v58, v50 row_newbcast:4 row_mask:0xf bank_mask:0x3
  v_perm_b32 v96, v57, v57, v20
  v_perm_b32 v97, v57, v57, v21
  v_mov_b32_dpp v58, v50 row_newbcast:5 row_mask:0xf bank_mask:0xc
  v_perm_b32 v98, v57, v57, v22
  v_perm_b32 v99, v57, v57, v23
  s_cbranch_vccnz L_tf_472
  s_cbranch_scc1 L_tm_473
  s_waitcnt vmcnt(3)
L_tm_473:
  s_waitcnt vmcnt(4)
L_tf_472:
  s_cbranch_scc1 L_te_474
  s_waitcnt vmcnt(5)
L_te_474:
  s_waitcnt vmcnt(7)
  global_load_dwordx4 v[132:135], v18, s[8:9] nt
  v_xor_b32 v18, 0x2000, v18
  v_mfma_f32_16x16x32_bf16 v[36:39], v[100:103], v[164:167], v[36:39]
  v_mov_b32_dpp v59, v50 row_newbcast:6 row_mask:0xf bank_mask:0x3
  v_perm_b32 v100, v58, v58, v20
  v_perm_b32 v101, v58, v58, v21
  v_mov_b32_dpp v59, v50 row_newbcast:7 row_mask:0xf bank_mask:0xc
  v_perm_b32 v102, v58, v58, v22
  v_perm_b32 v103, v58, v58, v23
  s_cbranch_vccnz L_tf_475
  s_cbranch_scc1 L_tm_476
  s_waitcnt vmcnt(3)
L_tm_476:
  s_waitcnt vmcnt(4)
L_tf_475:
  s_cbranch_scc1 L_te_477
  s_waitcnt vmcnt(5)
L_te_477:
  s_waitcnt vmcnt(7)
  global_load_dwordx4 v[136:139], v18, s[8:9] nt
  v_xor_b32 v18, 0x102400, v18
  v_mfma_f32_16x16x32_bf16 v[36:39], v[104:107], v[168:171], v[36:39]
  v_mov_b32_dpp v60, v50 row_newbcast:8 row_mask:0xf bank_mask:0x3
  v_perm_b32 v104, v59, v59, v20
  v_perm_b32 v105, v59, v59, v21
  v_mov_b32_dpp v60, v50 row_newbcast:9 row_mask:0xf bank_mask:0xc
  v_perm_b32 v106, v59, v59, v22
  v_perm_b32 v107, v59, v59, v23
  s_cbranch_vccnz L_tf_478
  s_cbranch_scc1 L_tm_479
  s_waitcnt vmcnt(3)
L_tm_479:
  s_waitcnt vmcnt(4)
L_tf_478:
  s_cbranch_scc1 L_te_480
  s_waitcnt vmcnt(5)
L_te_480:
  s_waitcnt vmcnt(7)
  global_load_dwordx4 v[140:143], v18, s[8:9] nt
  v_xor_b32 v18, 0x2000, v18
  v_mfma_f32_16x16x32_bf16 v[36:39], v[108:111], v[172:175], v[36:39]
  v_mov_b32_dpp v61, v50 row_newbcast:10 row_mask:0xf bank_mask:0x3
  v_perm_b32 v108, v60, v60, v20
  v_perm_b32 v109, v60, v60, v21
  v_mov_b32_dpp v61, v50 row_newbcast:11 row_mask:0xf bank_mask:0xc
  v_perm_b32 v110, v60, v60, v22
  v_perm_b32 v111, v60, v60, v23
  v_mov_b32 v8, 1
  s_mov_b64 exec, 1
  ds_add_u32 v2, v8 offset:3120
  s_mov_b64 exec, -1
  s_memrealtime s[58:59]
  ds_read_b64 v[252:253], v2 offset:3112
  s_cbranch_vccnz L_tf_481
  s_cbranch_scc1 L_tm_482
  s_waitcnt vmcnt(3)
L_tm_482:
  s_waitcnt vmcnt(4)
L_tf_481:
  s_cbranch_scc1 L_te_483
  s_waitcnt vmcnt(5)
L_te_483:
  s_waitcnt vmcnt(7)
  global_load_dwordx4 v[144:147], v18, s[8:9] nt
  v_xor_b32 v18, 0x2400, v18
  v_mfma_f32_16x16x32_bf16 v[36:39], v[112:115], v[176:179], v[36:39]
  v_mov_b32_dpp v62, v50 row_newbcast:12 row_mask:0xf bank_mask:0x3
  v_perm_b32 v112, v61, v61, v20
  v_perm_b32 v113, v61, v61, v21
  v_mov_b32_dpp v62, v50 row_newbcast:13 row_mask:0xf bank_mask:0xc
  v_perm_b32 v114, v61, v61, v22
  v_perm_b32 v115, v61, v61, v23
  s_cbranch_vccnz L_tf_484
  s_cbranch_scc1 L_tm_485
  s_waitcnt vmcnt(3)
L_tm_485:
  s_waitcnt vmcnt(4)
L_tf_484:
  s_cbranch_scc1 L_te_486
  s_waitcnt vmcnt(5)
L_te_486:
  s_waitcnt vmcnt(7)
  global_load_dwordx4 v[148:151], v18, s[8:9] nt
  v_xor_b32 v18, 0x2000, v18
  v_mfma_f32_16x16x32_bf16 v[36:39], v[116:119], v[180:183], v[36:39]
  v_mov_b32_dpp v63, v50 row_newbcast:14 row_mask:0xf bank_mask:0x3
  v_perm_b32 v116, v62, v62, v20
  v_perm_b32 v117, v62, v62, v21
  v_mov_b32_dpp v63, v50 row_newbcast:15 row_mask:0xf bank_mask:0xc
  v_perm_b32 v118, v62, v62, v22
  v_perm_b32 v119, v62, v62, v23
  s_waitcnt lgkmcnt(0)
  v_readfirstlane_b32 s54, v252
  v_readfirstlane_b32 s59, v253
  s_sub_u32 s57, s58, s54
  s_mul_i32 s33, s59, 23
  s_lshr_b32 s33, s33, 4
  s_cselect_b32 s57, s57, 0
  s_sub_u32 s57, s57, s33
  s_cmp_gt_i32 s57, 26
  s_cselect_b64 vcc, -1, 0
  s_cselect_b32 s33, s98, s99
  s_cmp_gt_i32 s57, s33
  s_cbranch_vccnz L_tf_487
  s_cbranch_scc1 L_tm_488
  s_waitcnt vmcnt(3)
L_tm_488:
  s_waitcnt vmcnt(4)
L_tf_487:
  s_cbranch_scc1 L_te_489
  s_waitcnt vmcnt(5)
L_te_489:
  s_waitcnt vmcnt(7)
  global_load_dwordx4 v[152:155], v18, s[8:9] nt
  v_xor_b32 v18, 0x112400, v18
  v_mfma_f32_16x16x32_bf16 v[36:39], v[120:123], v[184:187], v[36:39]
  v_perm_b32 v120, v63, v63, v20
  v_perm_b32 v121, v63, v63, v21
  v_perm_b32 v122, v63, v63, v22
  v_perm_b32 v123, v63, v63, v23
  s_cbranch_vccnz L_tf_490
  s_cbranch_scc1 L_tm_491
  s_waitcnt vmcnt(3)
L_tm_491:
  s_waitcnt vmcnt(4)
L_tf_490:
  s_cbranch_scc1 L_te_492
  s_waitcnt vmcnt(5)
L_te_492:
  s_waitcnt vmcnt(7)
  global_load_dwordx4 v[156:159], v18, s[8:9] nt
  v_xor_b32 v18, 0x2000, v18
  v_mfma_f32_16x16x32_bf16 v[36:39], v[92:95], v[124:127], v[36:39]
  v_mov_b32_dpp v56, v50 row_newbcast:0 row_mask:0xf bank_mask:0x3
  v_mov_b32_dpp v57, v50 row_newbcast:2 row_mask:0xf bank_mask:0x3
  s_nop 0
  v_mov_b32_dpp v56, v50 row_newbcast:1 row_mask:0xf bank_mask:0xc
  v_mov_b32_dpp v57, v50 row_newbcast:3 row_mask:0xf bank_mask:0xc
  v_perm_b32 v92, v56, v56, v24
  v_perm_b32 v93, v56, v56, v25
  v_perm_b32 v94, v56, v56, v26
  v_perm_b32 v95, v56, v56, v27
  s_cbranch_vccnz L_tf_493
  s_cbranch_scc1 L_tm_494
  s_waitcnt vmcnt(3)
L_tm_494:
  s_waitcnt vmcnt(4)
L_tf_493:
  s_cbranch_scc1 L_te_495
  s_waitcnt vmcnt(5)
L_te_495:
  s_waitcnt vmcnt(7)
  global_load_dwordx4 v[160:163], v18, s[8:9] nt
  v_xor_b32 v18, 0x2400, v18
  v_mfma_f32_16x16x32_bf16 v[36:39], v[96:99], v[128:131], v[36:39]
  v_mov_b32_dpp v58, v50 row_newbcast:4 row_mask:0xf bank_mask:0x3
  v_perm_b32 v96, v57, v57, v24
  v_perm_b32 v97, v57, v57, v25
  v_mov_b32_dpp v58, v50 row_newbcast:5 row_mask:0xf bank_mask:0xc
  v_perm_b32 v98, v57, v57, v26
  v_perm_b32 v99, v57, v57, v27
  s_cbranch_vccnz L_tf_496
  s_cbranch_scc1 L_tm_497
  s_waitcnt vmcnt(3)
L_tm_497:
  s_waitcnt vmcnt(4)
L_tf_496:
  s_cbranch_scc1 L_te_498
  s_waitcnt vmcnt(5)
L_te_498:
  s_waitcnt vmcnt(7)
  global_load_dwordx4 v[164:167], v18, s[8:9] nt
  v_xor_b32 v18, 0x2000, v18
  v_mfma_f32_16x16x32_bf16 v[36:39], v[100:103], v[132:135], v[36:39]
  v_mov_b32_dpp v59, v50 row_newbcast:6 row_mask:0xf bank_mask:0x3
  v_perm_b32 v100, v58, v58, v24
  v_perm_b32 v101, v58, v58, v25
  v_mov_b32_dpp v59, v50 row_newbcast:7 row_mask:0xf bank_mask:0xc
  v_perm_b32 v102, v58, v58, v26
  v_perm_b32 v103, v58, v58, v27
  s_mov_b32 s64, 0x07060500
  s_mov_b32 s65, 0x07060501
  s_mov_b32 s66, 0x07060502
  s_mov_b32 s67, 0x07060503
  v_and_b32 v7, 1, v1
  v_cmp_ne_u32 vcc, 0, v7
  v_mov_b32 v236, s62
  v_mov_b32 v7, s63
  v_cndmask_b32 v236, v236, v7, vcc
  v_bfe_u32 v239, v236, 24, 8
  v_bfe_u32 v238, v236, 16, 8
  v_bfe_u32 v237, v236, 8, 8
  v_bfe_u32 v236, v236, 0, 8
  v_and_b32 v7, 7, v1
  v_lshlrev_b32 v7, 7, v7
  v_lshrrev_b32 v8, 3, v1
  v_lshrrev_b32 v241, 3, v7
  v_lshl_add_u32 v241, v8, 8, v241
  s_lshl_b32 s34, s2, 11
  s_add_u32 s34, s34, 0x40000
  s_add_u32 s46, s28, s34
  s_addc_u32 s47, s29, 0
  v_lshrrev_b32 v243, 5, v7
  s_cmp_gt_i32 s57, 26
  s_cselect_b64 vcc, -1, 0
  s_cselect_b32 s33, s98, s99
  s_cmp_gt_i32 s57, s33
  s_cbranch_vccnz L_tf_499
  s_cbranch_scc1 L_tm_500
  s_waitcnt vmcnt(3)
L_tm_500:
  s_waitcnt vmcnt(4)
L_tf_499:
  s_cbranch_scc1 L_te_501
  s_waitcnt vmcnt(5)
L_te_501:
  s_waitcnt vmcnt(7)
  global_load_dwordx4 v[168:171], v18, s[8:9] nt
  v_xor_b32 v18, 0x102400, v18
  v_mfma_f32_16x16x32_bf16 v[36:39], v[104:107], v[136:139], v[36:39]
  v_mov_b32_dpp v60, v50 row_newbcast:8 row_mask:0xf bank_mask:0x3
  v_perm_b32 v104, v59, v59, v24
  v_perm_b32 v105, v59, v59, v25
  v_mov_b32_dpp v60, v50 row_newbcast:9 row_mask:0xf bank_mask:0xc
  v_perm_b32 v106, v59, v59, v26
  v_perm_b32 v107, v59, v59, v27
  s_cbranch_vccnz L_tf_502
  s_cbranch_scc1 L_tm_503
  s_waitcnt vmcnt(3)
L_tm_503:
  s_waitcnt vmcnt(4)
L_tf_502:
  s_cbranch_scc1 L_te_504
  s_waitcnt vmcnt(5)
L_te_504:
  s_waitcnt vmcnt(7)
  global_load_dwordx4 v[172:175], v18, s[8:9] nt
  v_xor_b32 v18, 0x2000, v18
  v_mfma_f32_16x16x32_bf16 v[36:39], v[108:111], v[140:143], v[36:39]
  v_mov_b32_dpp v61, v50 row_newbcast:10 row_mask:0xf bank_mask:0x3
  v_perm_b32 v108, v60, v60, v24
  v_perm_b32 v109, v60, v60, v25
  v_mov_b32_dpp v61, v50 row_newbcast:11 row_mask:0xf bank_mask:0xc
  v_perm_b32 v110, v60, v60, v26
  v_perm_b32 v111, v60, v60, v27
  s_memrealtime s[58:59]
  ds_read_b64 v[252:253], v2 offset:3112
  s_cbranch_vccnz L_tf_505
  s_cbranch_scc1 L_tm_506
  s_waitcnt vmcnt(3)
L_tm_506:
  s_waitcnt vmcnt(4)
L_tf_505:
  s_cbranch_scc1 L_te_507
  s_waitcnt vmcnt(5)
L_te_507:
  s_waitcnt vmcnt(7)
  global_load_dwordx4 v[176:179], v18, s[8:9] nt
  v_xor_b32 v18, 0x2400, v18
  v_mfma_f32_16x16x32_bf16 v[36:39], v[112:115], v[144:147], v[36:39]
  v_mov_b32_dpp v62, v50 row_newbcast:12 row_mask:0xf bank_mask:0x3
  v_perm_b32 v112, v61, v61, v24
  v_perm_b32 v113, v61, v61, v25
  v_mov_b32_dpp v62, v50 row_newbcast:13 row_mask:0xf bank_mask:0xc
  v_perm_b32 v114, v61, v61, v26
  v_perm_b32 v115, v61, v61, v27
  s_cbranch_vccnz L_tf_508
  s_cbranch_scc1 L_tm_509
  s_waitcnt vmcnt(3)
L_tm_509:
  s_waitcnt vmcnt(4)
L_tf_508:
  s_cbranch_scc1 L_te_510
  s_waitcnt vmcnt(5)
L_te_510:
  s_waitcnt vmcnt(7)
  global_load_dwordx4 v[180:183], v18, s[8:9] nt
  v_xor_b32 v18, 0x2000, v18
  v_mfma_f32_16x16x32_bf16 v[36:39], v[116:119], v[148:151], v[36:39]
  v_mov_b32_dpp v63, v50 row_newbcast:14 row_mask:0xf bank_mask:0x3
  v_perm_b32 v116, v62, v62, v24
  v_perm_b32 v117, v62, v62, v25
  v_mov_b32_dpp v63, v50 row_newbcast:15 row_mask:0xf bank_mask:0xc
  v_perm_b32 v118, v62, v62, v26
  v_perm_b32 v119, v62, v62, v27
  s_waitcnt lgkmcnt(0)
  v_readfirstlane_b32 s54, v252
  v_readfirstlane_b32 s59, v253
  s_sub_u32 s57, s58, s54
  s_mul_i32 s33, s59, 24
  s_lshr_b32 s33, s33, 4
  s_cselect_b32 s57, s57, 0
  s_sub_u32 s57, s57, s33
  s_cmp_gt_i32 s57, 26
  s_cselect_b64 vcc, -1, 0
  s_cselect_b32 s33, s98, s99
  s_cmp_gt_i32 s57, s33
  s_cbranch_vccnz L_tf_511
  s_cbranch_scc1 L_tm_512
  s_waitcnt vmcnt(3)
L_tm_512:
  s_waitcnt vmcnt(4)
L_tf_511:
  s_cbranch_scc1 L_te_513
  s_waitcnt vmcnt(5)
L_te_513:
  s_waitcnt vmcnt(7)
  global_load_dwordx4 v[184:187], v18, s[8:9] nt
  v_xor_b32 v18, 0x192400, v18
  v_mfma_f32_16x16x32_bf16 v[36:39], v[120:123], v[152:155], v[36:39]
  v_perm_b32 v120, v63, v63, v24
  v_perm_b32 v121, v63, v63, v25
  v_perm_b32 v122, v63, v63, v26
  v_perm_b32 v123, v63, v63, v27
  s_cbranch_vccnz L_tf_514
  s_cbranch_scc1 L_tm_515
  s_waitcnt vmcnt(3)
L_tm_515:
  s_waitcnt vmcnt(4)
L_tf_514:
  s_cbranch_scc1 L_te_516
  s_waitcnt vmcnt(5)
L_te_516:
  s_waitcnt vmcnt(7)
  global_load_dwordx4 v[124:127], v18, s[8:9] nt
  v_xor_b32 v18, 0x2000, v18
  v_mfma_f32_16x16x32_bf16 v[36:39], v[92:95], v[156:159], v[36:39]
  v_mov_b32_dpp v56, v51 row_newbcast:0 row_mask:0xf bank_mask:0x3
  v_mov_b32_dpp v57, v51 row_newbcast:2 row_mask:0xf bank_mask:0x3
  s_nop 0
  v_mov_b32_dpp v56, v51 row_newbcast:1 row_mask:0xf bank_mask:0xc
  v_mov_b32_dpp v57, v51 row_newbcast:3 row_mask:0xf bank_mask:0xc
  v_perm_b32 v92, v56, v56, v20
  v_perm_b32 v93, v56, v56, v21
  v_perm_b32 v94, v56, v56, v22
  v_perm_b32 v95, v56, v56, v23
  s_cbranch_vccnz L_tf_517
  s_cbranch_scc1 L_tm_518
  s_waitcnt vmcnt(3)
L_tm_518:
  s_waitcnt vmcnt(4)
L_tf_517:
  s_cbranch_scc1 L_te_519
  s_waitcnt vmcnt(5)
L_te_519:
  s_waitcnt vmcnt(7)
  global_load_dwordx4 v[128:131], v18, s[8:9] nt
  v_xor_b32 v18, 0x2400, v18
  v_mfma_f32_16x16x32_bf16 v[36:39], v[96:99], v[160:163], v[36:39]
  v_mov_b32_dpp v58, v51 row_newbcast:4 row_mask:0xf bank_mask:0x3
  v_perm_b32 v96, v57, v57, v20
  v_perm_b32 v97, v57, v57, v21
  v_mov_b32_dpp v58, v51 row_newbcast:5 row_mask:0xf bank_mask:0xc
  v_perm_b32 v98, v57, v57, v22
  v_perm_b32 v99, v57, v57, v23
  s_cbranch_vccnz L_tf_520
  s_cbranch_scc1 L_tm_521
  s_waitcnt vmcnt(3)
L_tm_521:
  s_waitcnt vmcnt(4)
L_tf_520:
  s_cbranch_scc1 L_te_522
  s_waitcnt vmcnt(5)
L_te_522:
  s_waitcnt vmcnt(7)
  global_load_dwordx4 v[132:135], v18, s[8:9] nt
  v_xor_b32 v18, 0x2000, v18
  v_mfma_f32_16x16x32_bf16 v[36:39], v[100:103], v[164:167], v[36:39]
  v_mov_b32_dpp v59, v51 row_newbcast:6 row_mask:0xf bank_mask:0x3
  v_perm_b32 v100, v58, v58, v20
  v_perm_b32 v101, v58, v58, v21
  v_mov_b32_dpp v59, v51 row_newbcast:7 row_mask:0xf bank_mask:0xc
  v_perm_b32 v102, v58, v58, v22
  v_perm_b32 v103, v58, v58, v23
  s_cbranch_vccnz L_tf_523
  s_cbranch_scc1 L_tm_524
  s_waitcnt vmcnt(3)
L_tm_524:
  s_waitcnt vmcnt(4)
L_tf_523:
  s_cbranch_scc1 L_te_525
  s_waitcnt vmcnt(5)
L_te_525:
  s_waitcnt vmcnt(7)
  global_load_dwordx4 v[136:139], v18, s[8:9] nt
  v_xor_b32 v18, 0x102400, v18
  v_mfma_f32_16x16x32_bf16 v[36:39], v[104:107], v[168:171], v[36:39]
  v_mov_b32_dpp v60, v51 row_newbcast:8 row_mask:0xf bank_mask:0x3
  v_perm_b32 v104, v59, v59, v20
  v_perm_b32 v105, v59, v59, v21
  v_mov_b32_dpp v60, v51 row_newbcast:9 row_mask:0xf bank_mask:0xc
  v_perm_b32 v106, v59, v59, v22
  v_perm_b32 v107, v59, v59, v23
  s_cbranch_vccnz L_tf_526
  s_cbranch_scc1 L_tm_527
  s_waitcnt vmcnt(3)
L_tm_527:
  s_waitcnt vmcnt(4)
L_tf_526:
  s_cbranch_scc1 L_te_528
  s_waitcnt vmcnt(5)
L_te_528:
  s_waitcnt vmcnt(7)
  global_load_dwordx4 v[140:143], v18, s[8:9] nt
  v_xor_b32 v18, 0x2000, v18
  v_mfma_f32_16x16x32_bf16 v[36:39], v[108:111], v[172:175], v[36:39]
  v_mov_b32_dpp v61, v51 row_newbcast:10 row_mask:0xf bank_mask:0x3
  v_perm_b32 v108, v60, v60, v20
  v_perm_b32 v109, v60, v60, v21
  v_mov_b32_dpp v61, v51 row_newbcast:11 row_mask:0xf bank_mask:0xc
  v_perm_b32 v110, v60, v60, v22
  v_perm_b32 v111, v60, v60, v23
  s_memrealtime s[58:59]
  ds_read_b64 v[252:253], v2 offset:3112
  s_cbranch_vccnz L_tf_529
  s_cbranch_scc1 L_tm_530
  s_waitcnt vmcnt(3)
L_tm_530:
  s_waitcnt vmcnt(4)
L_tf_529:
  s_cbranch_scc1 L_te_531
  s_waitcnt vmcnt(5)
L_te_531:
  s_waitcnt vmcnt(7)
  global_load_dwordx4 v[144:147], v18, s[8:9] nt
  v_xor_b32 v18, 0x2400, v18
  v_mfma_f32_16x16x32_bf16 v[36:39], v[112:115], v[176:179], v[36:39]
  v_mov_b32_dpp v62, v51 row_newbcast:12 row_mask:0xf bank_mask:0x3
  v_perm_b32 v112, v61, v61, v20
  v_perm_b32 v113, v61, v61, v21
  v_mov_b32_dpp v62, v51 row_newbcast:13 row_mask:0xf bank_mask:0xc
  v_perm_b32 v114, v61, v61, v22
  v_perm_b32 v115, v61, v61, v23
  s_cbranch_vccnz L_tf_532
  s_cbranch_scc1 L_tm_533
  s_waitcnt vmcnt(3)
L_tm_533:
  s_waitcnt vmcnt(4)
L_tf_532:
  s_cbranch_scc1 L_te_534
  s_waitcnt vmcnt(5)
L_te_534:
  s_waitcnt vmcnt(7)
  global_load_dwordx4 v[148:151], v18, s[8:9] nt
  v_xor_b32 v18, 0x2000, v18
  v_mfma_f32_16x16x32_bf16 v[36:39], v[116:119], v[180:183], v[36:39]
  v_mov_b32_dpp v63, v51 row_newbcast:14 row_mask:0xf bank_mask:0x3
  v_perm_b32 v116, v62, v62, v20
  v_perm_b32 v117, v62, v62, v21
  v_mov_b32_dpp v63, v51 row_newbcast:15 row_mask:0xf bank_mask:0xc
  v_perm_b32 v118, v62, v62, v22
  v_perm_b32 v119, v62, v62, v23
  s_waitcnt lgkmcnt(0)
  v_readfirstlane_b32 s54, v252
  v_readfirstlane_b32 s59, v253
  s_sub_u32 s57, s58, s54
  s_mul_i32 s33, s59, 25
  s_lshr_b32 s33, s33, 4
  s_cselect_b32 s57, s57, 0
  s_sub_u32 s57, s57, s33
  s_cmp_gt_i32 s57, 26
  s_cselect_b64 vcc, -1, 0
  s_cselect_b32 s33, s98, s99
  s_cmp_gt_i32 s57, s33
  s_cbranch_vccnz L_tf_535
  s_cbranch_scc1 L_tm_536
  s_waitcnt vmcnt(3)
L_tm_536:
  s_waitcnt vmcnt(4)
L_tf_535:
  s_cbranch_scc1 L_te_537
  s_waitcnt vmcnt(5)
L_te_537:
  s_waitcnt vmcnt(7)
  global_load_dwordx4 v[152:155], v18, s[8:9] nt
  v_xor_b32 v18, 0x112400, v18
  v_mfma_f32_16x16x32_bf16 v[36:39], v[120:123], v[184:187], v[36:39]
  v_perm_b32 v120, v63, v63, v20
  v_perm_b32 v121, v63, v63, v21
  v_perm_b32 v122, v63, v63, v22
  v_perm_b32 v123, v63, v63, v23
  s_cbranch_vccnz L_tf_538
  s_cbranch_scc1 L_tm_539
  s_waitcnt vmcnt(3)
L_tm_539:
  s_waitcnt vmcnt(4)
L_tf_538:
  s_cbranch_scc1 L_te_540
  s_waitcnt vmcnt(5)
L_te_540:
  s_waitcnt vmcnt(7)
  global_load_dwordx4 v[156:159], v18, s[8:9] nt
  v_xor_b32 v18, 0x2000, v18
  v_mfma_f32_16x16x32_bf16 v[36:39], v[92:95], v[124:127], v[36:39]
  v_mov_b32_dpp v56, v51 row_newbcast:0 row_mask:0xf bank_mask:0x3
  v_mov_b32_dpp v57, v51 row_newbcast:2 row_mask:0xf bank_mask:0x3
  s_nop 0
  v_mov_b32_dpp v56, v51 row_newbcast:1 row_mask:0xf bank_mask:0xc
  v_mov_b32_dpp v57, v51 row_newbcast:3 row_mask:0xf bank_mask:0xc
  v_perm_b32 v92, v56, v56, v24
  v_perm_b32 v93, v56, v56, v25
  v_perm_b32 v94, v56, v56, v26
  v_perm_b32 v95, v56, v56, v27
  v_mov_b32 v8, 1
  s_mov_b64 exec, 1
  ds_add_u32 v2, v8 offset:3084
  s_mov_b64 exec, -1
  s_cmp_gt_i32 s57, 26
  s_cselect_b64 vcc, -1, 0
  s_cselect_b32 s33, s98, s99
  s_cmp_gt_i32 s57, s33
  s_cbranch_vccnz L_tf_541
  s_cbranch_scc1 L_tm_542
  s_waitcnt vmcnt(3)
L_tm_542:
  s_waitcnt vmcnt(4)
L_tf_541:
  s_cbranch_scc1 L_te_543
  s_waitcnt vmcnt(5)
L_te_543:
  s_waitcnt vmcnt(7)
  global_load_dwordx4 v[160:163], v18, s[8:9] nt
  v_xor_b32 v18, 0x2400, v18
  v_mfma_f32_16x16x32_bf16 v[36:39], v[96:99], v[128:131], v[36:39]
  v_mov_b32_dpp v58, v51 row_newbcast:4 row_mask:0xf bank_mask:0x3
  v_perm_b32 v96, v57, v57, v24
  v_perm_b32 v97, v57, v57, v25
  v_mov_b32_dpp v58, v51 row_newbcast:5 row_mask:0xf bank_mask:0xc
  v_perm_b32 v98, v57, v57, v26
  v_perm_b32 v99, v57, v57, v27
  s_cbranch_vccnz L_tf_544
  s_cbranch_scc1 L_tm_545
  s_waitcnt vmcnt(3)
L_tm_545:
  s_waitcnt vmcnt(4)
L_tf_544:
  s_cbranch_scc1 L_te_546
  s_waitcnt vmcnt(5)
L_te_546:
  s_waitcnt vmcnt(7)
  global_load_dwordx4 v[164:167], v18, s[8:9] nt
  v_xor_b32 v18, 0x2000, v18
  v_mfma_f32_16x16x32_bf16 v[36:39], v[100:103], v[132:135], v[36:39]
  v_mov_b32_dpp v59, v51 row_newbcast:6 row_mask:0xf bank_mask:0x3
  v_perm_b32 v100, v58, v58, v24
  v_perm_b32 v101, v58, v58, v25
  v_mov_b32_dpp v59, v51 row_newbcast:7 row_mask:0xf bank_mask:0xc
  v_perm_b32 v102, v58, v58, v26
  v_perm_b32 v103, v58, v58, v27
  v_and_b32 v7, 1, v1
  v_cmp_ne_u32 vcc, 0, v7
  v_mov_b32 v240, s62
  v_mov_b32 v7, s63
  v_cndmask_b32 v240, v240, v7, vcc
  v_and_b32 v7, 8, v1
  v_cmp_ne_u32 vcc, 0, v7
  v_lshrrev_b32 v8, 5, v1
  s_nop 0
  v_cndmask_b32 v8, v8, 2, vcc
  v_bfe_u32 v7, v1, 2, 1
  v_lshl_add_u32 v7, v8, 1, v7
  v_bfe_u32 v8, v1, 4, 1
  v_lshl_add_u32 v7, v7, 1, v8
  v_lshlrev_b32 v7, 13, v7
  v_and_b32 v8, 3, v1
  v_lshl_add_u32 v242, v8, 4, v7
  s_lshr_b32 s34, s32, 3
  s_mul_i32 s34, s34, 9
  s_mul_i32 s35, s30, 3
  s_add_u32 s34, s34, s35
  s_lshl_b32 s34, s34, 15
  s_lshl_b32 s35, s56, 6
  s_add_u32 s34, s34, s35
  s_add_u32 s34, s34, 0xc0000
  s_add_u32 s48, s28, s34
  s_addc_u32 s49, s29, 0
  s_cmp_lg_u32 s30, 3
  s_cbranch_scc1 L_opt_547
  v_and_b32 v7, 1, v1
  v_cmp_ne_u32 vcc, 0, v7
  v_mov_b32 v240, s62
  v_mov_b32 v7, s63
  v_cndmask_b32 v240, v240, v7, vcc
  v_lshlrev_b32 v242, 8, v1
  s_lshl_b32 s33, s31, 15
  s_lshl_b32 s34, s32, 4
  s_add_u32 s33, s33, s34
  s_add_u32 s33, s33, 0x44000
  s_add_u32 s48, s28, s33
  s_addc_u32 s49, s29, 0
  s_bitcmp1_b32 s32, 0
  s_cselect_b32 s33, s63, s62
  v_mov_b32 v240, s33
  s_nop 1
L_opt_547:
  ds_read_b32 v7, v2 offset:3108
  s_waitcnt lgkmcnt(0)
  v_readfirstlane_b32 s61, v7
  s_cmp_gt_i32 s57, 26
  s_cselect_b64 vcc, -1, 0
  s_cselect_b32 s33, s98, s99
  s_cmp_gt_i32 s57, s33
  s_cbranch_vccnz L_tf_548
  s_cbranch_scc1 L_tm_549
  s_waitcnt vmcnt(3)
L_tm_549:
  s_waitcnt vmcnt(4)
L_tf_548:
  s_cbranch_scc1 L_te_550
  s_waitcnt vmcnt(5)
L_te_550:
  s_waitcnt vmcnt(7)
  global_load_dwordx4 v[168:171], v18, s[8:9] nt
  v_xor_b32 v18, 0x102400, v18
  v_mfma_f32_16x16x32_bf16 v[36:39], v[104:107], v[136:139], v[36:39]
  v_mov_b32_dpp v60, v51 row_newbcast:8 row_mask:0xf bank_mask:0x3
  v_perm_b32 v104, v59, v59, v24
  v_perm_b32 v105, v59, v59, v25
  v_mov_b32_dpp v60, v51 row_newbcast:9 row_mask:0xf bank_mask:0xc
  v_perm_b32 v106, v59, v59, v26
  v_perm_b32 v107, v59, v59, v27
  s_cbranch_vccnz L_tf_551
  s_cbranch_scc1 L_tm_552
  s_waitcnt vmcnt(3)
L_tm_552:
  s_waitcnt vmcnt(4)
L_tf_551:
  s_cbranch_scc1 L_te_553
  s_waitcnt vmcnt(5)
L_te_553:
  s_waitcnt vmcnt(7)
  global_load_dwordx4 v[172:175], v18, s[8:9] nt
  v_xor_b32 v18, 0x2000, v18
  v_mfma_f32_16x16x32_bf16 v[36:39], v[108:111], v[140:143], v[36:39]
  v_mov_b32_dpp v61, v51 row_newbcast:10 row_mask:0xf bank_mask:0x3
  v_perm_b32 v108, v60, v60, v24
  v_perm_b32 v109, v60, v60, v25
  v_mov_b32_dpp v61, v51 row_newbcast:11 row_mask:0xf bank_mask:0xc
  v_perm_b32 v110, v60, v60, v26
  v_perm_b32 v111, v60, v60, v27
  s_memrealtime s[58:59]
  ds_read_b64 v[252:253], v2 offset:3112
  s_cbranch_vccnz L_tf_554
  s_cbranch_scc1 L_tm_555
  s_waitcnt vmcnt(3)
L_tm_555:
  s_waitcnt vmcnt(4)
L_tf_554:
  s_cbranch_scc1 L_te_556
  s_waitcnt vmcnt(5)
L_te_556:
  s_waitcnt vmcnt(7)
  global_load_dwordx4 v[176:179], v18, s[8:9] nt
  v_xor_b32 v18, 0x2400, v18
  v_mfma_f32_16x16x32_bf16 v[36:39], v[112:115], v[144:147], v[36:39]
  v_mov_b32_dpp v62, v51 row_newbcast:12 row_mask:0xf bank_mask:0x3
  v_perm_b32 v112, v61, v61, v24
  v_perm_b32 v113, v61, v61, v25
  v_mov_b32_dpp v62, v51 row_newbcast:13 row_mask:0xf bank_mask:0xc
  v_perm_b32 v114, v61, v61, v26
  v_perm_b32 v115, v61, v61, v27
  s_cbranch_vccnz L_tf_557
  s_cbranch_scc1 L_tm_558
  s_waitcnt vmcnt(3)
L_tm_558:
  s_waitcnt vmcnt(4)
L_tf_557:
  s_cbranch_scc1 L_te_559
  s_waitcnt vmcnt(5)
L_te_559:
  s_waitcnt vmcnt(7)
  global_load_dwordx4 v[180:183], v18, s[8:9] nt
  v_xor_b32 v18, 0x2000, v18
  v_mfma_f32_16x16x32_bf16 v[36:39], v[116:119], v[148:151], v[36:39]
  v_mov_b32_dpp v63, v51 row_newbcast:14 row_mask:0xf bank_mask:0x3
  v_perm_b32 v116, v62, v62, v24
  v_perm_b32 v117, v62, v62, v25
  v_mov_b32_dpp v63, v51 row_newbcast:15 row_mask:0xf bank_mask:0xc
  v_perm_b32 v118, v62, v62, v26
  v_perm_b32 v119, v62, v62, v27
  s_waitcnt lgkmcnt(0)
  v_readfirstlane_b32 s54, v252
  v_readfirstlane_b32 s59, v253
  s_sub_u32 s57, s58, s54
  s_mul_i32 s33, s59, 26
  s_lshr_b32 s33, s33, 4
  s_cselect_b32 s57, s57, 0
  s_sub_u32 s57, s57, s33
  s_cmp_gt_i32 s57, 26
  s_cselect_b64 vcc, -1, 0
  s_cselect_b32 s33, s98, s99
  s_cmp_gt_i32 s57, s33
  s_cbranch_vccnz L_tf_560
  s_cbranch_scc1 L_tm_561
  s_waitcnt vmcnt(3)
L_tm_561:
  s_waitcnt vmcnt(4)
L_tf_560:
  s_cbranch_scc1 L_te_562
  s_waitcnt vmcnt(5)
L_te_562:
  s_waitcnt vmcnt(7)
  global_load_dwordx4 v[184:187], v18, s[8:9] nt
  v_xor_b32 v18, 0x596400, v18
  v_mfma_f32_16x16x32_bf16 v[36:39], v[120:123], v[152:155], v[36:39]
  v_perm_b32 v120, v63, v63, v24
  v_perm_b32 v121, v63, v63, v25
  v_perm_b32 v122, v63, v63, v26
  v_perm_b32 v123, v63, v63, v27
  s_cbranch_vccnz L_tf_563
  s_cbranch_scc1 L_tm_564
  s_waitcnt vmcnt(3)
L_tm_564:
  s_waitcnt vmcnt(4)
L_tf_563:
  s_cbranch_scc1 L_te_565
  s_waitcnt vmcnt(5)
L_te_565:
  s_waitcnt vmcnt(7)
  global_load_dwordx4 v[124:127], v18, s[8:9] nt
  v_xor_b32 v18, 0x2000, v18
  v_mfma_f32_16x16x32_bf16 v[36:39], v[92:95], v[156:159], v[36:39]
  v_mov_b32_dpp v56, v52 row_newbcast:0 row_mask:0xf bank_mask:0x3
  v_mov_b32_dpp v57, v52 row_newbcast:2 row_mask:0xf bank_mask:0x3
  s_nop 0
  v_mov_b32_dpp v56, v52 row_newbcast:1 row_mask:0xf bank_mask:0xc
  v_mov_b32_dpp v57, v52 row_newbcast:3 row_mask:0xf bank_mask:0xc
  v_perm_b32 v92, v56, v56, v20
  v_perm_b32 v93, v56, v56, v21
  v_perm_b32 v94, v56, v56, v22
  v_perm_b32 v95, v56, v56, v23
  s_cbranch_vccnz L_tf_566
  s_cbranch_scc1 L_tm_567
  s_waitcnt vmcnt(3)
L_tm_567:
  s_waitcnt vmcnt(4)
L_tf_566:
  s_cbranch_scc1 L_te_568
  s_waitcnt vmcnt(5)
L_te_568:
  s_waitcnt vmcnt(7)
  global_load_dwordx4 v[128:131], v18, s[8:9] nt
  v_xor_b32 v18, 0x2400, v18
  v_mfma_f32_16x16x32_bf16 v[36:39], v[96:99], v[160:163], v[36:39]
  v_mov_b32_dpp v58, v52 row_newbcast:4 row_mask:0xf bank_mask:0x3
  v_perm_b32 v96, v57, v57, v20
  v_perm_b32 v97, v57, v57, v21
  v_mov_b32_dpp v58, v52 row_newbcast:5 row_mask:0xf bank_mask:0xc
  v_perm_b32 v98, v57, v57, v22
  v_perm_b32 v99, v57, v57, v23
  s_cbranch_vccnz L_tf_569
  s_cbranch_scc1 L_tm_570
  s_waitcnt vmcnt(3)
L_tm_570:
  s_waitcnt vmcnt(4)
L_tf_569:
  s_cbranch_scc1 L_te_571
  s_waitcnt vmcnt(5)
L_te_571:
  s_waitcnt vmcnt(7)
  global_load_dwordx4 v[132:135], v18, s[8:9] nt
  v_xor_b32 v18, 0x2000, v18
  v_mfma_f32_16x16x32_bf16 v[36:39], v[100:103], v[164:167], v[36:39]
  v_mov_b32_dpp v59, v52 row_newbcast:6 row_mask:0xf bank_mask:0x3
  v_perm_b32 v100, v58, v58, v20
  v_perm_b32 v101, v58, v58, v21
  v_mov_b32_dpp v59, v52 row_newbcast:7 row_mask:0xf bank_mask:0xc
  v_perm_b32 v102, v58, v58, v22
  v_perm_b32 v103, v58, v58, v23
  s_cbranch_vccnz L_tf_572
  s_cbranch_scc1 L_tm_573
  s_waitcnt vmcnt(3)
L_tm_573:
  s_waitcnt vmcnt(4)
L_tf_572:
  s_cbranch_scc1 L_te_574
  s_waitcnt vmcnt(5)
L_te_574:
  s_waitcnt vmcnt(7)
  global_load_dwordx4 v[136:139], v18, s[8:9] nt
  v_xor_b32 v18, 0x102400, v18
  v_mfma_f32_16x16x32_bf16 v[36:39], v[104:107], v[168:171], v[36:39]
  v_mov_b32_dpp v60, v52 row_newbcast:8 row_mask:0xf bank_mask:0x3
  v_perm_b32 v104, v59, v59, v20
  v_perm_b32 v105, v59, v59, v21
  v_mov_b32_dpp v60, v52 row_newbcast:9 row_mask:0xf bank_mask:0xc
  v_perm_b32 v106, v59, v59, v22
  v_perm_b32 v107, v59, v59, v23
  s_cbranch_vccnz L_tf_575
  s_cbranch_scc1 L_tm_576
  s_waitcnt vmcnt(3)
L_tm_576:
  s_waitcnt vmcnt(4)
L_tf_575:
  s_cbranch_scc1 L_te_577
  s_waitcnt vmcnt(5)
L_te_577:
  s_waitcnt vmcnt(7)
  global_load_dwordx4 v[140:143], v18, s[8:9] nt
  v_xor_b32 v18, 0x2000, v18
  v_mfma_f32_16x16x32_bf16 v[36:39], v[108:111], v[172:175], v[36:39]
  v_mov_b32_dpp v61, v52 row_newbcast:10 row_mask:0xf bank_mask:0x3
  v_perm_b32 v108, v60, v60, v20
  v_perm_b32 v109, v60, v60, v21
  v_mov_b32_dpp v61, v52 row_newbcast:11 row_mask:0xf bank_mask:0xc
  v_perm_b32 v110, v60, v60, v22
  v_perm_b32 v111, v60, v60, v23
  s_memrealtime s[58:59]
  ds_read_b64 v[252:253], v2 offset:3112
  s_cbranch_vccnz L_tf_578
  s_cbranch_scc1 L_tm_579
  s_waitcnt vmcnt(3)
L_tm_579:
  s_waitcnt vmcnt(4)
L_tf_578:
  s_cbranch_scc1 L_te_580
  s_waitcnt vmcnt(5)
L_te_580:
  s_waitcnt vmcnt(7)
  global_load_dwordx4 v[144:147], v18, s[8:9] nt
  v_xor_b32 v18, 0x2400, v18
  v_mfma_f32_16x16x32_bf16 v[36:39], v[112:115], v[176:179], v[36:39]
  v_mov_b32_dpp v62, v52 row_newbcast:12 row_mask:0xf bank_mask:0x3
  v_perm_b32 v112, v61, v61, v20
  v_perm_b32 v113, v61, v61, v21
  v_mov_b32_dpp v62, v52 row_newbcast:13 row_mask:0xf bank_mask:0xc
  v_perm_b32 v114, v61, v61, v22
  v_perm_b32 v115, v61, v61, v23
  s_cbranch_vccnz L_tf_581
  s_cbranch_scc1 L_tm_582
  s_waitcnt vmcnt(3)
L_tm_582:
  s_waitcnt vmcnt(4)
L_tf_581:
  s_cbranch_scc1 L_te_583
  s_waitcnt vmcnt(5)
L_te_583:
  s_waitcnt vmcnt(7)
  global_load_dwordx4 v[148:151], v18, s[8:9] nt
  v_xor_b32 v18, 0x2000, v18
  v_mfma_f32_16x16x32_bf16 v[36:39], v[116:119], v[180:183], v[36:39]
  v_mov_b32_dpp v63, v52 row_newbcast:14 row_mask:0xf bank_mask:0x3
  v_perm_b32 v116, v62, v62, v20
  v_perm_b32 v117, v62, v62, v21
  v_mov_b32_dpp v63, v52 row_newbcast:15 row_mask:0xf bank_mask:0xc
  v_perm_b32 v118, v62, v62, v22
  v_perm_b32 v119, v62, v62, v23
  s_waitcnt lgkmcnt(0)
  v_readfirstlane_b32 s54, v252
  v_readfirstlane_b32 s59, v253
  s_sub_u32 s57, s58, s54
  s_mul_i32 s33, s59, 27
  s_lshr_b32 s33, s33, 4
  s_cselect_b32 s57, s57, 0
  s_sub_u32 s57, s57, s33
  s_cmp_gt_i32 s57, 26
  s_cselect_b64 vcc, -1, 0
  s_cselect_b32 s33, s98, s99
  s_cmp_gt_i32 s57, s33
  s_cbranch_vccnz L_tf_584
  s_cbranch_scc1 L_tm_585
  s_waitcnt vmcnt(3)
L_tm_585:
  s_waitcnt vmcnt(4)
L_tf_584:
  s_cbranch_scc1 L_te_586
  s_waitcnt vmcnt(5)
L_te_586:
  s_waitcnt vmcnt(7)
  global_load_dwordx4 v[152:155], v18, s[8:9] nt
  v_xor_b32 v18, 0x112400, v18
  v_mfma_f32_16x16x32_bf16 v[36:39], v[120:123], v[184:187], v[36:39]
  v_perm_b32 v120, v63, v63, v20
  v_perm_b32 v121, v63, v63, v21
  v_perm_b32 v122, v63, v63, v22
  v_perm_b32 v123, v63, v63, v23
  s_cbranch_vccnz L_tf_587
  s_cbranch_scc1 L_tm_588
  s_waitcnt vmcnt(3)
L_tm_588:
  s_waitcnt vmcnt(4)
L_tf_587:
  s_cbranch_scc1 L_te_589
  s_waitcnt vmcnt(5)
L_te_589:
  s_waitcnt vmcnt(7)
  global_load_dwordx4 v[156:159], v18, s[8:9] nt
  v_xor_b32 v18, 0x2000, v18
  v_mfma_f32_16x16x32_bf16 v[48:51], v[92:95], v[124:127], 0
  v_mov_b32_dpp v56, v52 row_newbcast:0 row_mask:0xf bank_mask:0x3
  v_mov_b32_dpp v57, v52 row_newbcast:2 row_mask:0xf bank_mask:0x3
  s_nop 0
  v_mov_b32_dpp v56, v52 row_newbcast:1 row_mask:0xf bank_mask:0xc
  v_mov_b32_dpp v57, v52 row_newbcast:3 row_mask:0xf bank_mask:0xc
  v_perm_b32 v92, v56, v56, v24
  v_perm_b32 v93, v56, v56, v25
  v_perm_b32 v94, v56, v56, v26
  v_perm_b32 v95, v56, v56, v27
  s_cmp_gt_i32 s57, 26
  s_cselect_b64 vcc, -1, 0
  s_cselect_b32 s33, s98, s99
  s_cmp_gt_i32 s57, s33
  s_cbranch_vccnz L_tf_590
  s_cbranch_scc1 L_tm_591
  s_waitcnt vmcnt(3)
L_tm_591:
  s_waitcnt vmcnt(4)
L_tf_590:
  s_cbranch_scc1 L_te_592
  s_waitcnt vmcnt(5)
L_te_592:
  s_waitcnt vmcnt(7)
  global_load_dwordx4 v[160:163], v18, s[8:9] nt
  v_xor_b32 v18, 0x2400, v18
  v_mfma_f32_16x16x32_bf16 v[48:51], v[96:99], v[128:131], v[48:51]
  v_mov_b32_dpp v58, v52 row_newbcast:4 row_mask:0xf bank_mask:0x3
  v_perm_b32 v96, v57, v57, v24
  v_perm_b32 v97, v57, v57, v25
  v_mov_b32_dpp v58, v52 row_newbcast:5 row_mask:0xf bank_mask:0xc
  v_perm_b32 v98, v57, v57, v26
  v_perm_b32 v99, v57, v57, v27
  s_cbranch_vccnz L_tf_593
  s_cbranch_scc1 L_tm_594
  s_waitcnt vmcnt(3)
L_tm_594:
  s_waitcnt vmcnt(4)
L_tf_593:
  s_cbranch_scc1 L_te_595
  s_waitcnt vmcnt(5)
L_te_595:
  s_waitcnt vmcnt(7)
  global_load_dwordx4 v[164:167], v18, s[8:9] nt
  v_xor_b32 v18, 0x2000, v18
  v_mfma_f32_16x16x32_bf16 v[48:51], v[100:103], v[132:135], v[48:51]
  v_mov_b32_dpp v59, v52 row_newbcast:6 row_mask:0xf bank_mask:0x3
  v_perm_b32 v100, v58, v58, v24
  v_perm_b32 v101, v58, v58, v25
  v_mov_b32_dpp v59, v52 row_newbcast:7 row_mask:0xf bank_mask:0xc
  v_perm_b32 v102, v58, v58, v26
  v_perm_b32 v103, v58, v58, v27
  s_cbranch_vccnz L_tf_596
  s_cbranch_scc1 L_tm_597
  s_waitcnt vmcnt(3)
L_tm_597:
  s_waitcnt vmcnt(4)
L_tf_596:
  s_cbranch_scc1 L_te_598
  s_waitcnt vmcnt(5)
L_te_598:
  s_waitcnt vmcnt(7)
  global_load_dwordx4 v[168:171], v18, s[8:9] nt
  v_xor_b32 v18, 0x102400, v18
  v_mfma_f32_16x16x32_bf16 v[48:51], v[104:107], v[136:139], v[48:51]
  v_mov_b32_dpp v60, v52 row_newbcast:8 row_mask:0xf bank_mask:0x3
  v_perm_b32 v104, v59, v59, v24
  v_perm_b32 v105, v59, v59, v25
  v_mov_b32_dpp v60, v52 row_newbcast:9 row_mask:0xf bank_mask:0xc
  v_perm_b32 v106, v59, v59, v26
  v_perm_b32 v107, v59, v59, v27
  s_cbranch_vccnz L_tf_599
  s_cbranch_scc1 L_tm_600
  s_waitcnt vmcnt(3)
L_tm_600:
  s_waitcnt vmcnt(4)
L_tf_599:
  s_cbranch_scc1 L_te_601
  s_waitcnt vmcnt(5)
L_te_601:
  s_waitcnt vmcnt(7)
  global_load_dwordx4 v[172:175], v18, s[8:9] nt
  v_xor_b32 v18, 0x2000, v18
  v_mfma_f32_16x16x32_bf16 v[48:51], v[108:111], v[140:143], v[48:51]
  v_mov_b32_dpp v61, v52 row_newbcast:10 row_mask:0xf bank_mask:0x3
  v_perm_b32 v108, v60, v60, v24
  v_perm_b32 v109, v60, v60, v25
  v_mov_b32_dpp v61, v52 row_newbcast:11 row_mask:0xf bank_mask:0xc
  v_perm_b32 v110, v60, v60, v26
  v_perm_b32 v111, v60, v60, v27
  s_memrealtime s[58:59]
  ds_read_b64 v[252:253], v2 offset:3112
  s_cbranch_vccnz L_tf_602
  s_cbranch_scc1 L_tm_603
  s_waitcnt vmcnt(3)
L_tm_603:
  s_waitcnt vmcnt(4)
L_tf_602:
  s_cbranch_scc1 L_te_604
  s_waitcnt vmcnt(5)
L_te_604:
  s_waitcnt vmcnt(7)
  global_load_dwordx4 v[176:179], v18, s[8:9] nt
  v_xor_b32 v18, 0x2400, v18
  v_mfma_f32_16x16x32_bf16 v[48:51], v[112:115], v[144:147], v[48:51]
  v_mov_b32_dpp v62, v52 row_newbcast:12 row_mask:0xf bank_mask:0x3
  v_perm_b32 v112, v61, v61, v24
  v_perm_b32 v113, v61, v61, v25
  v_mov_b32_dpp v62, v52 row_newbcast:13 row_mask:0xf bank_mask:0xc
  v_perm_b32 v114, v61, v61, v26
  v_perm_b32 v115, v61, v61, v27
  s_cbranch_vccnz L_tf_605
  s_cbranch_scc1 L_tm_606
  s_waitcnt vmcnt(3)
L_tm_606:
  s_waitcnt vmcnt(4)
L_tf_605:
  s_cbranch_scc1 L_te_607
  s_waitcnt vmcnt(5)
L_te_607:
  s_waitcnt vmcnt(7)
  global_load_dwordx4 v[180:183], v18, s[8:9] nt
  v_xor_b32 v18, 0x2000, v18
  v_mfma_f32_16x16x32_bf16 v[48:51], v[116:119], v[148:151], v[48:51]
  v_mov_b32_dpp v63, v52 row_newbcast:14 row_mask:0xf bank_mask:0x3
  v_perm_b32 v116, v62, v62, v24
  v_perm_b32 v117, v62, v62, v25
  v_mov_b32_dpp v63, v52 row_newbcast:15 row_mask:0xf bank_mask:0xc
  v_perm_b32 v118, v62, v62, v26
  v_perm_b32 v119, v62, v62, v27
  s_waitcnt lgkmcnt(0)
  v_readfirstlane_b32 s54, v252
  v_readfirstlane_b32 s59, v253
  s_sub_u32 s57, s58, s54
  s_mul_i32 s33, s59, 28
  s_lshr_b32 s33, s33, 4
  s_cselect_b32 s57, s57, 0
  s_sub_u32 s57, s57, s33
  s_cmp_lg_u32 s55, 0
  s_cbranch_scc1 L_opt_608
  s_add_u32 s58, s58, s62
  s_lshl_b32 s33, s3, 8
  s_add_u32 s33, s33, 164864
  v_mov_b32 v7, s33
  v_mov_b32 v8, s58
  s_mov_b64 exec, 1
  global_store_dword v7, v8, s[28:29] sc1
  s_mov_b64 exec, -1
  s_nop 1
L_opt_608:
  s_cmp_gt_i32 s57, 26
  s_cselect_b64 vcc, -1, 0
  s_cselect_b32 s33, s98, s99
  s_cmp_gt_i32 s57, s33
  s_cbranch_vccnz L_tf_609
  s_cbranch_scc1 L_tm_610
  s_waitcnt vmcnt(3)
L_tm_610:
  s_waitcnt vmcnt(4)
L_tf_609:
  s_cbranch_scc1 L_te_611
  s_waitcnt vmcnt(5)
L_te_611:
  s_waitcnt vmcnt(7)
  global_load_dwordx4 v[184:187], v18, s[8:9] nt
  v_xor_b32 v18, 0x192400, v18
  v_mfma_f32_16x16x32_bf16 v[48:51], v[120:123], v[152:155], v[48:51]
  v_perm_b32 v120, v63, v63, v24
  v_perm_b32 v121, v63, v63, v25
  v_perm_b32 v122, v63, v63, v26
  v_perm_b32 v123, v63, v63, v27
  s_cbranch_vccnz L_tf_612
  s_cbranch_scc1 L_tm_613
  s_waitcnt vmcnt(3)
L_tm_613:
  s_waitcnt vmcnt(4)
L_tf_612:
  s_cbranch_scc1 L_te_614
  s_waitcnt vmcnt(5)
L_te_614:
  s_waitcnt vmcnt(7)
  global_load_dwordx4 v[124:127], v18, s[8:9] nt
  v_xor_b32 v18, 0x2000, v18
  v_mfma_f32_16x16x32_bf16 v[48:51], v[92:95], v[156:159], v[48:51]
  v_mov_b32_dpp v56, v53 row_newbcast:0 row_mask:0xf bank_mask:0x3
  v_mov_b32_dpp v57, v53 row_newbcast:2 row_mask:0xf bank_mask:0x3
  s_nop 0
  v_mov_b32_dpp v56, v53 row_newbcast:1 row_mask:0xf bank_mask:0xc
  v_mov_b32_dpp v57, v53 row_newbcast:3 row_mask:0xf bank_mask:0xc
  v_perm_b32 v92, v56, v56, v20
  v_perm_b32 v93, v56, v56, v21
  v_perm_b32 v94, v56, v56, v22
  v_perm_b32 v95, v56, v56, v23
  s_cbranch_vccnz L_tf_615
  s_cbranch_scc1 L_tm_616
  s_waitcnt vmcnt(3)
L_tm_616:
  s_waitcnt vmcnt(4)
L_tf_615:
  s_cbranch_scc1 L_te_617
  s_waitcnt vmcnt(5)
L_te_617:
  s_waitcnt vmcnt(7)
  global_load_dwordx4 v[128:131], v18, s[8:9] nt
  v_xor_b32 v18, 0x2400, v18
  v_mfma_f32_16x16x32_bf16 v[48:51], v[96:99], v[160:163], v[48:51]
  v_mov_b32_dpp v58, v53 row_newbcast:4 row_mask:0xf bank_mask:0x3
  v_perm_b32 v96, v57, v57, v20
  v_perm_b32 v97, v57, v57, v21
  v_mov_b32_dpp v58, v53 row_newbcast:5 row_mask:0xf bank_mask:0xc
  v_perm_b32 v98, v57, v57, v22
  v_perm_b32 v99, v57, v57, v23
  s_cbranch_vccnz L_tf_618
  s_cbranch_scc1 L_tm_619
  s_waitcnt vmcnt(3)
L_tm_619:
  s_waitcnt vmcnt(4)
L_tf_618:
  s_cbranch_scc1 L_te_620
  s_waitcnt vmcnt(5)
L_te_620:
  s_waitcnt vmcnt(7)
  global_load_dwordx4 v[132:135], v18, s[8:9] nt
  v_xor_b32 v18, 0x2000, v18
  v_mfma_f32_16x16x32_bf16 v[48:51], v[100:103], v[164:167], v[48:51]
  v_mov_b32_dpp v59, v53 row_newbcast:6 row_mask:0xf bank_mask:0x3
  v_perm_b32 v100, v58, v58, v20
  v_perm_b32 v101, v58, v58, v21
  v_mov_b32_dpp v59, v53 row_newbcast:7 row_mask:0xf bank_mask:0xc
  v_perm_b32 v102, v58, v58, v22
  v_perm_b32 v103, v58, v58, v23
  s_cbranch_vccnz L_tf_621
  s_cbranch_scc1 L_tm_622
  s_waitcnt vmcnt(3)
L_tm_622:
  s_waitcnt vmcnt(4)
L_tf_621:
  s_cbranch_scc1 L_te_623
  s_waitcnt vmcnt(5)
L_te_623:
  s_waitcnt vmcnt(7)
  global_load_dwordx4 v[136:139], v18, s[8:9] nt
  v_xor_b32 v18, 0x102400, v18
  v_mfma_f32_16x16x32_bf16 v[48:51], v[104:107], v[168:171], v[48:51]
  v_mov_b32_dpp v60, v53 row_newbcast:8 row_mask:0xf bank_mask:0x3
  v_perm_b32 v104, v59, v59, v20
  v_perm_b32 v105, v59, v59, v21
  v_mov_b32_dpp v60, v53 row_newbcast:9 row_mask:0xf bank_mask:0xc
  v_perm_b32 v106, v59, v59, v22
  v_perm_b32 v107, v59, v59, v23
  s_cbranch_vccnz L_tf_624
  s_cbranch_scc1 L_tm_625
  s_waitcnt vmcnt(3)
L_tm_625:
  s_waitcnt vmcnt(4)
L_tf_624:
  s_cbranch_scc1 L_te_626
  s_waitcnt vmcnt(5)
L_te_626:
  s_waitcnt vmcnt(7)
  global_load_dwordx4 v[140:143], v18, s[8:9] nt
  v_xor_b32 v18, 0x2000, v18
  v_mfma_f32_16x16x32_bf16 v[48:51], v[108:111], v[172:175], v[48:51]
  v_mov_b32_dpp v61, v53 row_newbcast:10 row_mask:0xf bank_mask:0x3
  v_perm_b32 v108, v60, v60, v20
  v_perm_b32 v109, v60, v60, v21
  v_mov_b32_dpp v61, v53 row_newbcast:11 row_mask:0xf bank_mask:0xc
  v_perm_b32 v110, v60, v60, v22
  v_perm_b32 v111, v60, v60, v23
  s_memrealtime s[58:59]
  ds_read_b64 v[252:253], v2 offset:3112
  s_cbranch_vccnz L_tf_627
  s_cbranch_scc1 L_tm_628
  s_waitcnt vmcnt(3)
L_tm_628:
  s_waitcnt vmcnt(4)
L_tf_627:
  s_cbranch_scc1 L_te_629
  s_waitcnt vmcnt(5)
L_te_629:
  s_waitcnt vmcnt(7)
  global_load_dwordx4 v[144:147], v18, s[8:9] nt
  v_xor_b32 v18, 0x2400, v18
  v_mfma_f32_16x16x32_bf16 v[48:51], v[112:115], v[176:179], v[48:51]
  v_mov_b32_dpp v62, v53 row_newbcast:12 row_mask:0xf bank_mask:0x3
  v_perm_b32 v112, v61, v61, v20
  v_perm_b32 v113, v61, v61, v21
  v_mov_b32_dpp v62, v53 row_newbcast:13 row_mask:0xf bank_mask:0xc
  v_perm_b32 v114, v61, v61, v22
  v_perm_b32 v115, v61, v61, v23
  s_cbranch_vccnz L_tf_630
  s_cbranch_scc1 L_tm_631
  s_waitcnt vmcnt(3)
L_tm_631:
  s_waitcnt vmcnt(4)
L_tf_630:
  s_cbranch_scc1 L_te_632
  s_waitcnt vmcnt(5)
L_te_632:
  s_waitcnt vmcnt(7)
  global_load_dwordx4 v[148:151], v18, s[8:9] nt
  v_xor_b32 v18, 0x2000, v18
  v_mfma_f32_16x16x32_bf16 v[48:51], v[116:119], v[180:183], v[48:51]
  v_mov_b32_dpp v63, v53 row_newbcast:14 row_mask:0xf bank_mask:0x3
  v_perm_b32 v116, v62, v62, v20
  v_perm_b32 v117, v62, v62, v21
  v_mov_b32_dpp v63, v53 row_newbcast:15 row_mask:0xf bank_mask:0xc
  v_perm_b32 v118, v62, v62, v22
  v_perm_b32 v119, v62, v62, v23
  s_waitcnt lgkmcnt(0)
  v_readfirstlane_b32 s54, v252
  v_readfirstlane_b32 s59, v253
  s_sub_u32 s57, s58, s54
  s_mul_i32 s33, s59, 29
  s_lshr_b32 s33, s33, 4
  s_cselect_b32 s57, s57, 0
  s_sub_u32 s57, s57, s33
  s_cmp_gt_i32 s57, 26
  s_cselect_b64 vcc, -1, 0
  s_cselect_b32 s33, s98, s99
  s_cmp_gt_i32 s57, s33
  s_cbranch_vccnz L_tf_633
  s_cbranch_scc1 L_tm_634
  s_waitcnt vmcnt(3)
L_tm_634:
  s_waitcnt vmcnt(4)
L_tf_633:
  s_cbranch_scc1 L_te_635
  s_waitcnt vmcnt(5)
L_te_635:
  s_waitcnt vmcnt(7)
  global_load_dwordx4 v[152:155], v18, s[8:9] nt
  v_xor_b32 v18, 0x112400, v18
  v_mfma_f32_16x16x32_bf16 v[48:51], v[120:123], v[184:187], v[48:51]
  v_perm_b32 v120, v63, v63, v20
  v_perm_b32 v121, v63, v63, v21
  v_perm_b32 v122, v63, v63, v22
  v_perm_b32 v123, v63, v63, v23
  s_cbranch_vccnz L_tf_636
  s_cbranch_scc1 L_tm_637
  s_waitcnt vmcnt(3)
L_tm_637:
  s_waitcnt vmcnt(4)
L_tf_636:
  s_cbranch_scc1 L_te_638
  s_waitcnt vmcnt(5)
L_te_638:
  s_waitcnt vmcnt(7)
  global_load_dwordx4 v[156:159], v18, s[8:9] nt
  v_xor_b32 v18, 0x2000, v18
  v_mfma_f32_16x16x32_bf16 v[48:51], v[92:95], v[124:127], v[48:51]
  v_mov_b32_dpp v56, v53 row_newbcast:0 row_mask:0xf bank_mask:0x3
  v_mov_b32_dpp v57, v53 row_newbcast:2 row_mask:0xf bank_mask:0x3
  s_nop 0
  v_mov_b32_dpp v56, v53 row_newbcast:1 row_mask:0xf bank_mask:0xc
  v_mov_b32_dpp v57, v53 row_newbcast:3 row_mask:0xf bank_mask:0xc
  v_perm_b32 v92, v56, v56, v24
  v_perm_b32 v93, v56, v56, v25
  v_perm_b32 v94, v56, v56, v26
  v_perm_b32 v95, v56, v56, v27
  s_cbranch_vccnz L_tf_639
  s_cbranch_scc1 L_tm_640
  s_waitcnt vmcnt(3)
L_tm_640:
  s_waitcnt vmcnt(4)
L_tf_639:
  s_cbranch_scc1 L_te_641
  s_waitcnt vmcnt(5)
L_te_641:
  s_waitcnt vmcnt(7)
  global_load_dwordx4 v[160:163], v18, s[8:9] nt
  v_xor_b32 v18, 0x2400, v18
  v_mfma_f32_16x16x32_bf16 v[48:51], v[96:99], v[128:131], v[48:51]
  v_mov_b32_dpp v58, v53 row_newbcast:4 row_mask:0xf bank_mask:0x3
  v_perm_b32 v96, v57, v57, v24
  v_perm_b32 v97, v57, v57, v25
  v_mov_b32_dpp v58, v53 row_newbcast:5 row_mask:0xf bank_mask:0xc
  v_perm_b32 v98, v57, v57, v26
  v_perm_b32 v99, v57, v57, v27
  s_cbranch_vccnz L_tf_642
  s_cbranch_scc1 L_tm_643
  s_waitcnt vmcnt(3)
L_tm_643:
  s_waitcnt vmcnt(4)
L_tf_642:
  s_cbranch_scc1 L_te_644
  s_waitcnt vmcnt(5)
L_te_644:
  s_waitcnt vmcnt(7)
  global_load_dwordx4 v[164:167], v18, s[8:9] nt
  v_xor_b32 v18, 0x2000, v18
  v_mfma_f32_16x16x32_bf16 v[48:51], v[100:103], v[132:135], v[48:51]
  v_mov_b32_dpp v59, v53 row_newbcast:6 row_mask:0xf bank_mask:0x3
  v_perm_b32 v100, v58, v58, v24
  v_perm_b32 v101, v58, v58, v25
  v_mov_b32_dpp v59, v53 row_newbcast:7 row_mask:0xf bank_mask:0xc
  v_perm_b32 v102, v58, v58, v26
  v_perm_b32 v103, v58, v58, v27
  s_cbranch_vccnz L_tf_645
  s_cbranch_scc1 L_tm_646
  s_waitcnt vmcnt(3)
L_tm_646:
  s_waitcnt vmcnt(4)
L_tf_645:
  s_cbranch_scc1 L_te_647
  s_waitcnt vmcnt(5)
L_te_647:
  s_waitcnt vmcnt(7)
  global_load_dwordx4 v[168:171], v18, s[8:9] nt
  v_xor_b32 v18, 0x102400, v18
  v_mfma_f32_16x16x32_bf16 v[48:51], v[104:107], v[136:139], v[48:51]
  v_mov_b32_dpp v60, v53 row_newbcast:8 row_mask:0xf bank_mask:0x3
  v_perm_b32 v104, v59, v59, v24
  v_perm_b32 v105, v59, v59, v25
  v_mov_b32_dpp v60, v53 row_newbcast:9 row_mask:0xf bank_mask:0xc
  v_perm_b32 v106, v59, v59, v26
  v_perm_b32 v107, v59, v59, v27
  s_cbranch_vccnz L_tf_648
  s_cbranch_scc1 L_tm_649
  s_waitcnt vmcnt(3)
L_tm_649:
  s_waitcnt vmcnt(4)
L_tf_648:
  s_cbranch_scc1 L_te_650
  s_waitcnt vmcnt(5)
L_te_650:
  s_waitcnt vmcnt(7)
  global_load_dwordx4 v[172:175], v18, s[8:9] nt
  v_xor_b32 v18, 0x2000, v18
  v_mfma_f32_16x16x32_bf16 v[48:51], v[108:111], v[140:143], v[48:51]
  v_mov_b32_dpp v61, v53 row_newbcast:10 row_mask:0xf bank_mask:0x3
  v_perm_b32 v108, v60, v60, v24
  v_perm_b32 v109, v60, v60, v25
  v_mov_b32_dpp v61, v53 row_newbcast:11 row_mask:0xf bank_mask:0xc
  v_perm_b32 v110, v60, v60, v26
  v_perm_b32 v111, v60, v60, v27
  v_mov_b32 v8, 1
  s_mov_b64 exec, 1
  ds_add_u32 v2, v8 offset:3120
  s_mov_b64 exec, -1
  s_memrealtime s[58:59]
  ds_read_b64 v[252:253], v2 offset:3112
  s_cbranch_vccnz L_tf_651
  s_cbranch_scc1 L_tm_652
  s_waitcnt vmcnt(3)
L_tm_652:
  s_waitcnt vmcnt(4)
L_tf_651:
  s_cbranch_scc1 L_te_653
  s_waitcnt vmcnt(5)
L_te_653:
  s_waitcnt vmcnt(7)
  global_load_dwordx4 v[176:179], v18, s[8:9] nt
  v_xor_b32 v18, 0x2400, v18
  v_mfma_f32_16x16x32_bf16 v[48:51], v[112:115], v[144:147], v[48:51]
  v_mov_b32_dpp v62, v53 row_newbcast:12 row_mask:0xf bank_mask:0x3
  v_perm_b32 v112, v61, v61, v24
  v_perm_b32 v113, v61, v61, v25
  v_mov_b32_dpp v62, v53 row_newbcast:13 row_mask:0xf bank_mask:0xc
  v_perm_b32 v114, v61, v61, v26
  v_perm_b32 v115, v61, v61, v27
  s_cbranch_vccnz L_tf_654
  s_cbranch_scc1 L_tm_655
  s_waitcnt vmcnt(3)
L_tm_655:
  s_waitcnt vmcnt(4)
L_tf_654:
  s_cbranch_scc1 L_te_656
  s_waitcnt vmcnt(5)
L_te_656:
  s_waitcnt vmcnt(7)
  global_load_dwordx4 v[180:183], v18, s[8:9] nt
  v_xor_b32 v18, 0x2000, v18
  v_mfma_f32_16x16x32_bf16 v[48:51], v[116:119], v[148:151], v[48:51]
  v_mov_b32_dpp v63, v53 row_newbcast:14 row_mask:0xf bank_mask:0x3
  v_perm_b32 v116, v62, v62, v24
  v_perm_b32 v117, v62, v62, v25
  v_mov_b32_dpp v63, v53 row_newbcast:15 row_mask:0xf bank_mask:0xc
  v_perm_b32 v118, v62, v62, v26
  v_perm_b32 v119, v62, v62, v27
  s_waitcnt lgkmcnt(0)
  v_readfirstlane_b32 s54, v252
  v_readfirstlane_b32 s59, v253
  s_sub_u32 s57, s58, s54
  s_mul_i32 s33, s59, 30
  s_lshr_b32 s33, s33, 4
  s_cselect_b32 s57, s57, 0
  s_sub_u32 s57, s57, s33
  s_cmp_gt_i32 s57, 26
  s_cselect_b64 vcc, -1, 0
  s_cselect_b32 s33, s98, s99
  s_cmp_gt_i32 s57, s33
  s_cbranch_vccnz L_tf_657
  s_cbranch_scc1 L_tm_658
  s_waitcnt vmcnt(3)
L_tm_658:
  s_waitcnt vmcnt(4)
L_tf_657:
  s_cbranch_scc1 L_te_659
  s_waitcnt vmcnt(5)
L_te_659:
  s_waitcnt vmcnt(7)
  global_load_dwordx4 v[184:187], v18, s[8:9] nt
  v_xor_b32 v18, 0x196400, v18
  v_mfma_f32_16x16x32_bf16 v[48:51], v[120:123], v[152:155], v[48:51]
  v_perm_b32 v120, v63, v63, v24
  v_perm_b32 v121, v63, v63, v25
  v_perm_b32 v122, v63, v63, v26
  v_perm_b32 v123, v63, v63, v27
  s_cbranch_vccnz L_tf_660
  s_cbranch_scc1 L_tm_661
  s_waitcnt vmcnt(3)
L_tm_661:
  s_waitcnt vmcnt(4)
L_tf_660:
  s_cbranch_scc1 L_te_662
  s_waitcnt vmcnt(5)
L_te_662:
  s_waitcnt vmcnt(7)
  global_load_dwordx4 v[124:127], v18, s[8:9] nt
  v_xor_b32 v18, 0x2000, v18
  v_mfma_f32_16x16x32_bf16 v[48:51], v[92:95], v[156:159], v[48:51]
  v_mov_b32_dpp v56, v54 row_newbcast:0 row_mask:0xf bank_mask:0x3
  v_mov_b32_dpp v57, v54 row_newbcast:2 row_mask:0xf bank_mask:0x3
  s_nop 0
  v_mov_b32_dpp v56, v54 row_newbcast:1 row_mask:0xf bank_mask:0xc
  v_mov_b32_dpp v57, v54 row_newbcast:3 row_mask:0xf bank_mask:0xc
  v_perm_b32 v92, v56, v56, v20
  v_perm_b32 v93, v56, v56, v21
  v_perm_b32 v94, v56, v56, v22
  v_perm_b32 v95, v56, v56, v23
  s_cbranch_vccnz L_tf_663
  s_cbranch_scc1 L_tm_664
  s_waitcnt vmcnt(3)
L_tm_664:
  s_waitcnt vmcnt(4)
L_tf_663:
  s_cbranch_scc1 L_te_665
  s_waitcnt vmcnt(5)
L_te_665:
  s_waitcnt vmcnt(7)
  global_load_dwordx4 v[128:131], v18, s[8:9] nt
  v_xor_b32 v18, 0x2400, v18
  v_mfma_f32_16x16x32_bf16 v[48:51], v[96:99], v[160:163], v[48:51]
  v_mov_b32_dpp v58, v54 row_newbcast:4 row_mask:0xf bank_mask:0x3
  v_perm_b32 v96, v57, v57, v20
  v_perm_b32 v97, v57, v57, v21
  v_mov_b32_dpp v58, v54 row_newbcast:5 row_mask:0xf bank_mask:0xc
  v_perm_b32 v98, v57, v57, v22
  v_perm_b32 v99, v57, v57, v23
  s_cbranch_vccnz L_tf_666
  s_cbranch_scc1 L_tm_667
  s_waitcnt vmcnt(3)
L_tm_667:
  s_waitcnt vmcnt(4)
L_tf_666:
  s_cbranch_scc1 L_te_668
  s_waitcnt vmcnt(5)
L_te_668:
  s_waitcnt vmcnt(7)
  global_load_dwordx4 v[132:135], v18, s[8:9] nt
  v_xor_b32 v18, 0x2000, v18
  v_mfma_f32_16x16x32_bf16 v[48:51], v[100:103], v[164:167], v[48:51]
  v_mov_b32_dpp v59, v54 row_newbcast:6 row_mask:0xf bank_mask:0x3
  v_perm_b32 v100, v58, v58, v20
  v_perm_b32 v101, v58, v58, v21
  v_mov_b32_dpp v59, v54 row_newbcast:7 row_mask:0xf bank_mask:0xc
  v_perm_b32 v102, v58, v58, v22
  v_perm_b32 v103, v58, v58, v23
  s_cbranch_vccnz L_tf_669
  s_cbranch_scc1 L_tm_670
  s_waitcnt vmcnt(3)
L_tm_670:
  s_waitcnt vmcnt(4)
L_tf_669:
  s_cbranch_scc1 L_te_671
  s_waitcnt vmcnt(5)
L_te_671:
  s_waitcnt vmcnt(7)
  global_load_dwordx4 v[136:139], v18, s[8:9] nt
  v_xor_b32 v18, 0x102400, v18
  v_mfma_f32_16x16x32_bf16 v[48:51], v[104:107], v[168:171], v[48:51]
  v_mov_b32_dpp v60, v54 row_newbcast:8 row_mask:0xf bank_mask:0x3
  v_perm_b32 v104, v59, v59, v20
  v_perm_b32 v105, v59, v59, v21
  v_mov_b32_dpp v60, v54 row_newbcast:9 row_mask:0xf bank_mask:0xc
  v_perm_b32 v106, v59, v59, v22
  v_perm_b32 v107, v59, v59, v23
  s_cbranch_vccnz L_tf_672
  s_cbranch_scc1 L_tm_673
  s_waitcnt vmcnt(3)
L_tm_673:
  s_waitcnt vmcnt(4)
L_tf_672:
  s_cbranch_scc1 L_te_674
  s_waitcnt vmcnt(5)
L_te_674:
  s_waitcnt vmcnt(7)
  global_load_dwordx4 v[140:143], v18, s[8:9] nt
  v_xor_b32 v18, 0x2000, v18
  v_mfma_f32_16x16x32_bf16 v[48:51], v[108:111], v[172:175], v[48:51]
  v_mov_b32_dpp v61, v54 row_newbcast:10 row_mask:0xf bank_mask:0x3
  v_perm_b32 v108, v60, v60, v20
  v_perm_b32 v109, v60, v60, v21
  v_mov_b32_dpp v61, v54 row_newbcast:11 row_mask:0xf bank_mask:0xc
  v_perm_b32 v110, v60, v60, v22
  v_perm_b32 v111, v60, v60, v23
  s_memrealtime s[58:59]
  ds_read_b64 v[252:253], v2 offset:3112
  s_cbranch_vccnz L_tf_675
  s_cbranch_scc1 L_tm_676
  s_waitcnt vmcnt(3)
L_tm_676:
  s_waitcnt vmcnt(4)
L_tf_675:
  s_cbranch_scc1 L_te_677
  s_waitcnt vmcnt(5)
L_te_677:
  s_waitcnt vmcnt(7)
  global_load_dwordx4 v[144:147], v18, s[8:9] nt
  v_xor_b32 v18, 0x2400, v18
  v_mfma_f32_16x16x32_bf16 v[48:51], v[112:115], v[176:179], v[48:51]
  v_mov_b32_dpp v62, v54 row_newbcast:12 row_mask:0xf bank_mask:0x3
  v_perm_b32 v112, v61, v61, v20
  v_perm_b32 v113, v61, v61, v21
  v_mov_b32_dpp v62, v54 row_newbcast:13 row_mask:0xf bank_mask:0xc
  v_perm_b32 v114, v61, v61, v22
  v_perm_b32 v115, v61, v61, v23
  s_cbranch_vccnz L_tf_678
  s_cbranch_scc1 L_tm_679
  s_waitcnt vmcnt(3)
L_tm_679:
  s_waitcnt vmcnt(4)
L_tf_678:
  s_cbranch_scc1 L_te_680
  s_waitcnt vmcnt(5)
L_te_680:
  s_waitcnt vmcnt(7)
  global_load_dwordx4 v[148:151], v18, s[8:9] nt
  v_xor_b32 v18, 0x2000, v18
  v_mfma_f32_16x16x32_bf16 v[48:51], v[116:119], v[180:183], v[48:51]
  v_mov_b32_dpp v63, v54 row_newbcast:14 row_mask:0xf bank_mask:0x3
  v_perm_b32 v116, v62, v62, v20
  v_perm_b32 v117, v62, v62, v21
  v_mov_b32_dpp v63, v54 row_newbcast:15 row_mask:0xf bank_mask:0xc
  v_perm_b32 v118, v62, v62, v22
  v_perm_b32 v119, v62, v62, v23
  s_waitcnt lgkmcnt(0)
  v_readfirstlane_b32 s54, v252
  v_readfirstlane_b32 s59, v253
  s_sub_u32 s57, s58, s54
  s_mul_i32 s33, s59, 31
  s_lshr_b32 s33, s33, 4
  s_cselect_b32 s57, s57, 0
  s_sub_u32 s57, s57, s33
  s_cmp_gt_i32 s57, 26
  s_cselect_b64 vcc, -1, 0
  s_cselect_b32 s33, s98, s99
  s_cmp_gt_i32 s57, s33
  s_cbranch_vccnz L_tf_681
  s_cbranch_scc1 L_tm_682
  s_waitcnt vmcnt(3)
L_tm_682:
  s_waitcnt vmcnt(4)
L_tf_681:
  s_cbranch_scc1 L_te_683
  s_waitcnt vmcnt(5)
L_te_683:
  s_waitcnt vmcnt(7)
  global_load_dwordx4 v[152:155], v18, s[8:9] nt
  v_xor_b32 v18, 0x112400, v18
  v_mfma_f32_16x16x32_bf16 v[48:51], v[120:123], v[184:187], v[48:51]
  v_perm_b32 v120, v63, v63, v20
  v_perm_b32 v121, v63, v63, v21
  v_perm_b32 v122, v63, v63, v22
  v_perm_b32 v123, v63, v63, v23
  s_cbranch_vccnz L_tf_684
  s_cbranch_scc1 L_tm_685
  s_waitcnt vmcnt(3)
L_tm_685:
  s_waitcnt vmcnt(4)
L_tf_684:
  s_cbranch_scc1 L_te_686
  s_waitcnt vmcnt(5)
L_te_686:
  s_waitcnt vmcnt(7)
  global_load_dwordx4 v[156:159], v18, s[8:9] nt
  v_xor_b32 v18, 0x2000, v18
  v_mfma_f32_16x16x32_bf16 v[48:51], v[92:95], v[124:127], v[48:51]
  v_mov_b32_dpp v56, v54 row_newbcast:0 row_mask:0xf bank_mask:0x3
  v_mov_b32_dpp v57, v54 row_newbcast:2 row_mask:0xf bank_mask:0x3
  s_nop 0
  v_mov_b32_dpp v56, v54 row_newbcast:1 row_mask:0xf bank_mask:0xc
  v_mov_b32_dpp v57, v54 row_newbcast:3 row_mask:0xf bank_mask:0xc
  v_perm_b32 v92, v56, v56, v24
  v_perm_b32 v93, v56, v56, v25
  v_perm_b32 v94, v56, v56, v26
  v_perm_b32 v95, v56, v56, v27
  s_cbranch_vccnz L_tf_687
  s_cbranch_scc1 L_tm_688
  s_waitcnt vmcnt(3)
L_tm_688:
  s_waitcnt vmcnt(4)
L_tf_687:
  s_cbranch_scc1 L_te_689
  s_waitcnt vmcnt(5)
L_te_689:
  s_waitcnt vmcnt(7)
  global_load_dwordx4 v[160:163], v18, s[8:9] nt
  v_xor_b32 v18, 0x2400, v18
  v_mfma_f32_16x16x32_bf16 v[48:51], v[96:99], v[128:131], v[48:51]
  v_mov_b32_dpp v58, v54 row_newbcast:4 row_mask:0xf bank_mask:0x3
  v_perm_b32 v96, v57, v57, v24
  v_perm_b32 v97, v57, v57, v25
  v_mov_b32_dpp v58, v54 row_newbcast:5 row_mask:0xf bank_mask:0xc
  v_perm_b32 v98, v57, v57, v26
  v_perm_b32 v99, v57, v57, v27
  s_cbranch_vccnz L_tf_690
  s_cbranch_scc1 L_tm_691
  s_waitcnt vmcnt(3)
L_tm_691:
  s_waitcnt vmcnt(4)
L_tf_690:
  s_cbranch_scc1 L_te_692
  s_waitcnt vmcnt(5)
L_te_692:
  s_waitcnt vmcnt(7)
  global_load_dwordx4 v[164:167], v18, s[8:9] nt
  v_xor_b32 v18, 0x2000, v18
  v_mfma_f32_16x16x32_bf16 v[48:51], v[100:103], v[132:135], v[48:51]
  v_mov_b32_dpp v59, v54 row_newbcast:6 row_mask:0xf bank_mask:0x3
  v_perm_b32 v100, v58, v58, v24
  v_perm_b32 v101, v58, v58, v25
  v_mov_b32_dpp v59, v54 row_newbcast:7 row_mask:0xf bank_mask:0xc
  v_perm_b32 v102, v58, v58, v26
  v_perm_b32 v103, v58, v58, v27
  s_cbranch_vccnz L_tf_693
  s_cbranch_scc1 L_tm_694
  s_waitcnt vmcnt(3)
L_tm_694:
  s_waitcnt vmcnt(4)
L_tf_693:
  s_cbranch_scc1 L_te_695
  s_waitcnt vmcnt(5)
L_te_695:
  s_waitcnt vmcnt(7)
  global_load_dwordx4 v[168:171], v18, s[8:9] nt
  v_xor_b32 v18, 0x102400, v18
  v_mfma_f32_16x16x32_bf16 v[48:51], v[104:107], v[136:139], v[48:51]
  v_mov_b32_dpp v60, v54 row_newbcast:8 row_mask:0xf bank_mask:0x3
  v_perm_b32 v104, v59, v59, v24
  v_perm_b32 v105, v59, v59, v25
  v_mov_b32_dpp v60, v54 row_newbcast:9 row_mask:0xf bank_mask:0xc
  v_perm_b32 v106, v59, v59, v26
  v_perm_b32 v107, v59, v59, v27
  s_cbranch_vccnz L_tf_696
  s_cbranch_scc1 L_tm_697
  s_waitcnt vmcnt(3)
L_tm_697:
  s_waitcnt vmcnt(4)
L_tf_696:
  s_cbranch_scc1 L_te_698
  s_waitcnt vmcnt(5)
L_te_698:
  s_waitcnt vmcnt(7)
  global_load_dwordx4 v[172:175], v18, s[8:9] nt
  v_xor_b32 v18, 0x2000, v18
  v_mfma_f32_16x16x32_bf16 v[48:51], v[108:111], v[140:143], v[48:51]
  v_mov_b32_dpp v61, v54 row_newbcast:10 row_mask:0xf bank_mask:0x3
  v_perm_b32 v108, v60, v60, v24
  v_perm_b32 v109, v60, v60, v25
  v_mov_b32_dpp v61, v54 row_newbcast:11 row_mask:0xf bank_mask:0xc
  v_perm_b32 v110, v60, v60, v26
  v_perm_b32 v111, v60, v60, v27
  s_memrealtime s[58:59]
  ds_read_b64 v[252:253], v2 offset:3112
  s_cbranch_vccnz L_tf_699
  s_cbranch_scc1 L_tm_700
  s_waitcnt vmcnt(3)
L_tm_700:
  s_waitcnt vmcnt(4)
L_tf_699:
  s_cbranch_scc1 L_te_701
  s_waitcnt vmcnt(5)
L_te_701:
  s_waitcnt vmcnt(7)
  global_load_dwordx4 v[176:179], v18, s[8:9] nt
  v_xor_b32 v18, 0x2400, v18
  v_mfma_f32_16x16x32_bf16 v[48:51], v[112:115], v[144:147], v[48:51]
  v_mov_b32_dpp v62, v54 row_newbcast:12 row_mask:0xf bank_mask:0x3
  v_perm_b32 v112, v61, v61, v24
  v_perm_b32 v113, v61, v61, v25
  v_mov_b32_dpp v62, v54 row_newbcast:13 row_mask:0xf bank_mask:0xc
  v_perm_b32 v114, v61, v61, v26
  v_perm_b32 v115, v61, v61, v27
  s_cbranch_vccnz L_tf_702
  s_cbranch_scc1 L_tm_703
  s_waitcnt vmcnt(3)
L_tm_703:
  s_waitcnt vmcnt(4)
L_tf_702:
  s_cbranch_scc1 L_te_704
  s_waitcnt vmcnt(5)
L_te_704:
  s_waitcnt vmcnt(7)
  global_load_dwordx4 v[180:183], v18, s[8:9] nt
  v_xor_b32 v18, 0x2000, v18
  v_mfma_f32_16x16x32_bf16 v[48:51], v[116:119], v[148:151], v[48:51]
  v_mov_b32_dpp v63, v54 row_newbcast:14 row_mask:0xf bank_mask:0x3
  v_perm_b32 v116, v62, v62, v24
  v_perm_b32 v117, v62, v62, v25
  v_mov_b32_dpp v63, v54 row_newbcast:15 row_mask:0xf bank_mask:0xc
  v_perm_b32 v118, v62, v62, v26
  v_perm_b32 v119, v62, v62, v27
  s_waitcnt lgkmcnt(0)
  v_readfirstlane_b32 s54, v252
  v_readfirstlane_b32 s59, v253
  s_sub_u32 s57, s58, s54
  s_mul_i32 s33, s59, 32
  s_lshr_b32 s33, s33, 4
  s_cselect_b32 s57, s57, 0
  s_sub_u32 s57, s57, s33
  s_cmp_gt_i32 s57, 26
  s_cselect_b64 vcc, -1, 0
  s_cselect_b32 s33, s98, s99
  s_cmp_gt_i32 s57, s33
  s_cbranch_vccnz L_tf_705
  s_cbranch_scc1 L_tm_706
  s_waitcnt vmcnt(3)
L_tm_706:
  s_waitcnt vmcnt(4)
L_tf_705:
  s_cbranch_scc1 L_te_707
  s_waitcnt vmcnt(5)
L_te_707:
  s_waitcnt vmcnt(7)
  global_load_dwordx4 v[184:187], v18, s[8:9] nt
  v_xor_b32 v18, 0x192400, v18
  v_mfma_f32_16x16x32_bf16 v[48:51], v[120:123], v[152:155], v[48:51]
  v_perm_b32 v120, v63, v63, v24
  v_perm_b32 v121, v63, v63, v25
  v_perm_b32 v122, v63, v63, v26
  v_perm_b32 v123, v63, v63, v27
  s_cbranch_vccnz L_tf_708
  s_cbranch_scc1 L_tm_709
  s_waitcnt vmcnt(3)
L_tm_709:
  s_waitcnt vmcnt(4)
L_tf_708:
  s_cbranch_scc1 L_te_710
  s_waitcnt vmcnt(5)
L_te_710:
  s_waitcnt vmcnt(7)
  global_load_dwordx4 v[124:127], v18, s[8:9] nt
  v_xor_b32 v18, 0x2000, v18
  v_mfma_f32_16x16x32_bf16 v[48:51], v[92:95], v[156:159], v[48:51]
  v_mov_b32_dpp v56, v55 row_newbcast:0 row_mask:0xf bank_mask:0x3
  v_mov_b32_dpp v57, v55 row_newbcast:2 row_mask:0xf bank_mask:0x3
  s_nop 0
  v_mov_b32_dpp v56, v55 row_newbcast:1 row_mask:0xf bank_mask:0xc
  v_mov_b32_dpp v57, v55 row_newbcast:3 row_mask:0xf bank_mask:0xc
  v_perm_b32 v92, v56, v56, v20
  v_perm_b32 v93, v56, v56, v21
  v_perm_b32 v94, v56, v56, v22
  v_perm_b32 v95, v56, v56, v23
  s_cbranch_vccnz L_tf_711
  s_cbranch_scc1 L_tm_712
  s_waitcnt vmcnt(3)
L_tm_712:
  s_waitcnt vmcnt(4)
L_tf_711:
  s_cbranch_scc1 L_te_713
  s_waitcnt vmcnt(5)
L_te_713:
  s_waitcnt vmcnt(7)
  global_load_dwordx4 v[128:131], v18, s[8:9] nt
  v_xor_b32 v18, 0x2400, v18
  v_mfma_f32_16x16x32_bf16 v[48:51], v[96:99], v[160:163], v[48:51]
  v_mov_b32_dpp v58, v55 row_newbcast:4 row_mask:0xf bank_mask:0x3
  v_perm_b32 v96, v57, v57, v20
  v_perm_b32 v97, v57, v57, v21
  v_mov_b32_dpp v58, v55 row_newbcast:5 row_mask:0xf bank_mask:0xc
  v_perm_b32 v98, v57, v57, v22
  v_perm_b32 v99, v57, v57, v23
  s_cbranch_vccnz L_tf_714
  s_cbranch_scc1 L_tm_715
  s_waitcnt vmcnt(3)
L_tm_715:
  s_waitcnt vmcnt(4)
L_tf_714:
  s_cbranch_scc1 L_te_716
  s_waitcnt vmcnt(5)
L_te_716:
  s_waitcnt vmcnt(7)
  global_load_dwordx4 v[132:135], v18, s[8:9] nt
  v_xor_b32 v18, 0x2000, v18
  v_mfma_f32_16x16x32_bf16 v[48:51], v[100:103], v[164:167], v[48:51]
  v_mov_b32_dpp v59, v55 row_newbcast:6 row_mask:0xf bank_mask:0x3
  v_perm_b32 v100, v58, v58, v20
  v_perm_b32 v101, v58, v58, v21
  v_mov_b32_dpp v59, v55 row_newbcast:7 row_mask:0xf bank_mask:0xc
  v_perm_b32 v102, v58, v58, v22
  v_perm_b32 v103, v58, v58, v23
  global_load_dwordx4 v[136:139], v18, s[8:9] nt
  v_xor_b32 v18, 0x102400, v18
  s_mov_b32 s35, 8388608
L_lw_717:
  ds_read_b32 v7, v2 offset:3092
  s_waitcnt lgkmcnt(0)
  v_readfirstlane_b32 s34, v7
  s_cmp_eq_u32 s34, 1
  s_cbranch_scc1 L_lwd_718
  s_sub_u32 s35, s35, 1
  s_cbranch_scc0 L_lw_717
L_lwd_718:
  ds_read_b64 v[44:45], v6 offset:3328
  v_mov_b32_dpp v7, v11 quad_perm:[0,0,0,0] row_mask:0x3 bank_mask:0xf
  s_nop 1
  v_mov_b32_dpp v7, v11 quad_perm:[1,1,1,1] row_mask:0xc bank_mask:0xf
  v_mov_b32_dpp v14, v9 quad_perm:[0,0,0,0] row_mask:0x3 bank_mask:0xf
  s_nop 1
  v_mov_b32_dpp v14, v9 quad_perm:[1,1,1,1] row_mask:0xc bank_mask:0xf
  s_waitcnt lgkmcnt(0)
  v_sub_f32 v14, v14, v44
  v_sub_f32 v7, v7, v45
  v_sub_f32 v8, v17, v44
  v_exp_f32 v14, v14
  v_exp_f32 v7, v7
  v_exp_f32 v8, v8
  s_nop 0
  v_mul_f32 v36, v36, v8
  v_mul_f32 v37, v37, v8
  v_mul_f32 v38, v38, v8
  v_mul_f32 v39, v39, v8
  v_mul_f32 v40, v40, v7
  v_mul_f32 v41, v41, v7
  v_mul_f32 v42, v42, v7
  v_mul_f32 v43, v43, v7
  ds_write_b128 v15, v[40:43] offset:8192
  s_cmp_gt_i32 s57, 26
  s_cselect_b64 vcc, -1, 0
  s_cselect_b32 s33, s98, s99
  s_cmp_gt_i32 s57, s33
  s_waitcnt vmcnt(8)
  v_mfma_f32_16x16x32_bf16 v[48:51], v[104:107], v[168:171], v[48:51]
  v_mov_b32_dpp v60, v55 row_newbcast:8 row_mask:0xf bank_mask:0x3
  v_perm_b32 v104, v59, v59, v20
  v_perm_b32 v105, v59, v59, v21
  v_mov_b32_dpp v60, v55 row_newbcast:9 row_mask:0xf bank_mask:0xc
  v_perm_b32 v106, v59, v59, v22
  v_perm_b32 v107, v59, v59, v23
  s_cbranch_vccnz L_tf_719
  s_cbranch_scc1 L_tm_720
  s_waitcnt vmcnt(3)
L_tm_720:
  s_waitcnt vmcnt(4)
L_tf_719:
  s_cbranch_scc1 L_te_721
  s_waitcnt vmcnt(5)
L_te_721:
  s_waitcnt vmcnt(7)
  global_load_dwordx4 v[140:143], v18, s[8:9] nt
  v_xor_b32 v18, 0x2000, v18
  v_mfma_f32_16x16x32_bf16 v[48:51], v[108:111], v[172:175], v[48:51]
  v_mov_b32_dpp v61, v55 row_newbcast:10 row_mask:0xf bank_mask:0x3
  v_perm_b32 v108, v60, v60, v20
  v_perm_b32 v109, v60, v60, v21
  v_mov_b32_dpp v61, v55 row_newbcast:11 row_mask:0xf bank_mask:0xc
  v_perm_b32 v110, v60, v60, v22
  v_perm_b32 v111, v60, v60, v23
  s_memrealtime s[58:59]
  ds_read_b64 v[252:253], v2 offset:3112
  s_cbranch_vccnz L_tf_722
  s_cbranch_scc1 L_tm_723
  s_waitcnt vmcnt(3)
L_tm_723:
  s_waitcnt vmcnt(4)
L_tf_722:
  s_cbranch_scc1 L_te_724
  s_waitcnt vmcnt(5)
L_te_724:
  s_waitcnt vmcnt(7)
  global_load_dwordx4 v[144:147], v18, s[8:9] nt
  v_xor_b32 v18, 0x2400, v18
  v_mfma_f32_16x16x32_bf16 v[48:51], v[112:115], v[176:179], v[48:51]
  v_mov_b32_dpp v62, v55 row_newbcast:12 row_mask:0xf bank_mask:0x3
  v_perm_b32 v112, v61, v61, v20
  v_perm_b32 v113, v61, v61, v21
  v_mov_b32_dpp v62, v55 row_newbcast:13 row_mask:0xf bank_mask:0xc
  v_perm_b32 v114, v61, v61, v22
  v_perm_b32 v115, v61, v61, v23
  s_cbranch_vccnz L_tf_725
  s_cbranch_scc1 L_tm_726
  s_waitcnt vmcnt(3)
L_tm_726:
  s_waitcnt vmcnt(4)
L_tf_725:
  s_cbranch_scc1 L_te_727
  s_waitcnt vmcnt(5)
L_te_727:
  s_waitcnt vmcnt(7)
  global_load_dwordx4 v[148:151], v18, s[8:9] nt
  v_xor_b32 v18, 0x2000, v18
  v_mfma_f32_16x16x32_bf16 v[48:51], v[116:119], v[180:183], v[48:51]
  v_mov_b32_dpp v63, v55 row_newbcast:14 row_mask:0xf bank_mask:0x3
  v_perm_b32 v116, v62, v62, v20
  v_perm_b32 v117, v62, v62, v21
  v_mov_b32_dpp v63, v55 row_newbcast:15 row_mask:0xf bank_mask:0xc
  v_perm_b32 v118, v62, v62, v22
  v_perm_b32 v119, v62, v62, v23
  s_waitcnt lgkmcnt(0)
  v_readfirstlane_b32 s54, v252
  v_readfirstlane_b32 s59, v253
  s_sub_u32 s57, s58, s54
  s_mul_i32 s33, s59, 33
  s_lshr_b32 s33, s33, 4
  s_cselect_b32 s57, s57, 0
  s_sub_u32 s57, s57, s33
  s_cmp_gt_i32 s57, 26
  s_cselect_b64 vcc, -1, 0
  s_cselect_b32 s33, s98, s99
  s_cmp_gt_i32 s57, s33
  s_cbranch_vccnz L_tf_728
  s_cbranch_scc1 L_tm_729
  s_waitcnt vmcnt(3)
L_tm_729:
  s_waitcnt vmcnt(4)
L_tf_728:
  s_cbranch_scc1 L_te_730
  s_waitcnt vmcnt(5)
L_te_730:
  s_waitcnt vmcnt(7)
  global_load_dwordx4 v[152:155], v18, s[8:9] nt
  v_xor_b32 v18, 0x112400, v18
  v_mfma_f32_16x16x32_bf16 v[48:51], v[120:123], v[184:187], v[48:51]
  v_perm_b32 v120, v63, v63, v20
  v_perm_b32 v121, v63, v63, v21
  v_perm_b32 v122, v63, v63, v22
  v_perm_b32 v123, v63, v63, v23
  s_cbranch_vccnz L_tf_731
  s_cbranch_scc1 L_tm_732
  s_waitcnt vmcnt(3)
L_tm_732:
  s_waitcnt vmcnt(4)
L_tf_731:
  s_cbranch_scc1 L_te_733
  s_waitcnt vmcnt(5)
L_te_733:
  s_waitcnt vmcnt(7)
  global_load_dwordx4 v[156:159], v18, s[8:9] nt
  v_xor_b32 v18, 0x2000, v18
  v_mfma_f32_16x16x32_bf16 v[48:51], v[92:95], v[124:127], v[48:51]
  v_mov_b32_dpp v56, v55 row_newbcast:0 row_mask:0xf bank_mask:0x3
  v_mov_b32_dpp v57, v55 row_newbcast:2 row_mask:0xf bank_mask:0x3
  s_nop 0
  v_mov_b32_dpp v56, v55 row_newbcast:1 row_mask:0xf bank_mask:0xc
  v_mov_b32_dpp v57, v55 row_newbcast:3 row_mask:0xf bank_mask:0xc
  v_perm_b32 v92, v56, v56, v24
  v_perm_b32 v93, v56, v56, v25
  v_perm_b32 v94, v56, v56, v26
  v_perm_b32 v95, v56, v56, v27
  s_cbranch_vccnz L_tf_734
  s_cbranch_scc1 L_tm_735
  s_waitcnt vmcnt(3)
L_tm_735:
  s_waitcnt vmcnt(4)
L_tf_734:
  s_cbranch_scc1 L_te_736
  s_waitcnt vmcnt(5)
L_te_736:
  s_waitcnt vmcnt(7)
  global_load_dwordx4 v[160:163], v18, s[8:9] nt
  v_xor_b32 v18, 0x2400, v18
  v_mfma_f32_16x16x32_bf16 v[48:51], v[96:99], v[128:131], v[48:51]
  v_mov_b32_dpp v58, v55 row_newbcast:4 row_mask:0xf bank_mask:0x3
  v_perm_b32 v96, v57, v57, v24
  v_perm_b32 v97, v57, v57, v25
  v_mov_b32_dpp v58, v55 row_newbcast:5 row_mask:0xf bank_mask:0xc
  v_perm_b32 v98, v57, v57, v26
  v_perm_b32 v99, v57, v57, v27
  s_cbranch_vccnz L_tf_737
  s_cbranch_scc1 L_tm_738
  s_waitcnt vmcnt(3)
L_tm_738:
  s_waitcnt vmcnt(4)
L_tf_737:
  s_cbranch_scc1 L_te_739
  s_waitcnt vmcnt(5)
L_te_739:
  s_waitcnt vmcnt(7)
  global_load_dwordx4 v[164:167], v18, s[8:9] nt
  v_xor_b32 v18, 0x2000, v18
  v_mfma_f32_16x16x32_bf16 v[48:51], v[100:103], v[132:135], v[48:51]
  v_mov_b32_dpp v59, v55 row_newbcast:6 row_mask:0xf bank_mask:0x3
  v_perm_b32 v100, v58, v58, v24
  v_perm_b32 v101, v58, v58, v25
  v_mov_b32_dpp v59, v55 row_newbcast:7 row_mask:0xf bank_mask:0xc
  v_perm_b32 v102, v58, v58, v26
  v_perm_b32 v103, v58, v58, v27
  s_cbranch_vccnz L_tf_740
  s_cbranch_scc1 L_tm_741
  s_waitcnt vmcnt(3)
L_tm_741:
  s_waitcnt vmcnt(4)
L_tf_740:
  s_cbranch_scc1 L_te_742
  s_waitcnt vmcnt(5)
L_te_742:
  s_waitcnt vmcnt(7)
  global_load_dwordx4 v[168:171], v18, s[8:9] nt
  v_xor_b32 v18, 0x102400, v18
  v_mfma_f32_16x16x32_bf16 v[48:51], v[104:107], v[136:139], v[48:51]
  v_mov_b32_dpp v60, v55 row_newbcast:8 row_mask:0xf bank_mask:0x3
  v_perm_b32 v104, v59, v59, v24
  v_perm_b32 v105, v59, v59, v25
  v_mov_b32_dpp v60, v55 row_newbcast:9 row_mask:0xf bank_mask:0xc
  v_perm_b32 v106, v59, v59, v26
  v_perm_b32 v107, v59, v59, v27
  s_cbranch_vccnz L_tf_743
  s_cbranch_scc1 L_tm_744
  s_waitcnt vmcnt(3)
L_tm_744:
  s_waitcnt vmcnt(4)
L_tf_743:
  s_cbranch_scc1 L_te_745
  s_waitcnt vmcnt(5)
L_te_745:
  s_waitcnt vmcnt(7)
  global_load_dwordx4 v[172:175], v18, s[8:9] nt
  v_xor_b32 v18, 0x2000, v18
  v_mfma_f32_16x16x32_bf16 v[48:51], v[108:111], v[140:143], v[48:51]
  v_mov_b32_dpp v61, v55 row_newbcast:10 row_mask:0xf bank_mask:0x3
  v_perm_b32 v108, v60, v60, v24
  v_perm_b32 v109, v60, v60, v25
  v_mov_b32_dpp v61, v55 row_newbcast:11 row_mask:0xf bank_mask:0xc
  v_perm_b32 v110, v60, v60, v26
  v_perm_b32 v111, v60, v60, v27
  s_memrealtime s[58:59]
  ds_read_b64 v[252:253], v2 offset:3112
  s_cbranch_vccnz L_tf_746
  s_cbranch_scc1 L_tm_747
  s_waitcnt vmcnt(3)
L_tm_747:
  s_waitcnt vmcnt(4)
L_tf_746:
  s_cbranch_scc1 L_te_748
  s_waitcnt vmcnt(5)
L_te_748:
  s_waitcnt vmcnt(7)
  global_load_dwordx4 v[176:179], v18, s[8:9] nt
  v_xor_b32 v18, 0x2400, v18
  v_mfma_f32_16x16x32_bf16 v[48:51], v[112:115], v[144:147], v[48:51]
  v_mov_b32_dpp v62, v55 row_newbcast:12 row_mask:0xf bank_mask:0x3
  v_perm_b32 v112, v61, v61, v24
  v_perm_b32 v113, v61, v61, v25
  v_mov_b32_dpp v62, v55 row_newbcast:13 row_mask:0xf bank_mask:0xc
  v_perm_b32 v114, v61, v61, v26
  v_perm_b32 v115, v61, v61, v27
  s_cbranch_vccnz L_tf_749
  s_cbranch_scc1 L_tm_750
  s_waitcnt vmcnt(3)
L_tm_750:
  s_waitcnt vmcnt(4)
L_tf_749:
  s_cbranch_scc1 L_te_751
  s_waitcnt vmcnt(5)
L_te_751:
  s_waitcnt vmcnt(7)
  global_load_dwordx4 v[180:183], v18, s[8:9] nt
  v_xor_b32 v18, 0x2000, v18
  v_mfma_f32_16x16x32_bf16 v[48:51], v[116:119], v[148:151], v[48:51]
  v_mov_b32_dpp v63, v55 row_newbcast:14 row_mask:0xf bank_mask:0x3
  v_perm_b32 v116, v62, v62, v24
  v_perm_b32 v117, v62, v62, v25
  v_mov_b32_dpp v63, v55 row_newbcast:15 row_mask:0xf bank_mask:0xc
  v_perm_b32 v118, v62, v62, v26
  v_perm_b32 v119, v62, v62, v27
  s_waitcnt lgkmcnt(0)
  v_readfirstlane_b32 s54, v252
  v_readfirstlane_b32 s59, v253
  s_sub_u32 s57, s58, s54
  s_mul_i32 s33, s59, 34
  s_lshr_b32 s33, s33, 4
  s_cselect_b32 s57, s57, 0
  s_sub_u32 s57, s57, s33
  s_cmp_gt_i32 s57, 26
  s_cselect_b64 vcc, -1, 0
  s_cselect_b32 s33, s98, s99
  s_cmp_gt_i32 s57, s33
  s_cbranch_vccnz L_tf_752
  s_cbranch_scc1 L_tm_753
  s_waitcnt vmcnt(3)
L_tm_753:
  s_waitcnt vmcnt(4)
L_tf_752:
  s_cbranch_scc1 L_te_754
  s_waitcnt vmcnt(5)
L_te_754:
  s_waitcnt vmcnt(7)
  global_load_dwordx4 v[184:187], v18, s[8:9] nt
  v_mfma_f32_16x16x32_bf16 v[48:51], v[120:123], v[152:155], v[48:51]
  v_perm_b32 v120, v63, v63, v24
  v_perm_b32 v121, v63, v63, v25
  v_perm_b32 v122, v63, v63, v26
  v_perm_b32 v123, v63, v63, v27
  s_cbranch_vccnz L_tf_755
  s_cbranch_scc1 L_tm_756
  s_waitcnt vmcnt(3)
L_tm_756:
  s_waitcnt vmcnt(4)
L_tf_755:
  s_cbranch_scc1 L_te_757
  s_waitcnt vmcnt(5)
L_te_757:
  s_waitcnt vmcnt(7)
  s_mov_b64 exec, s[50:51]
  global_load_dwordx4 v[188:191], v19, s[10:11] offset:0 nt
  s_mov_b64 exec, -1
  v_mfma_f32_16x16x32_bf16 v[48:51], v[92:95], v[156:159], v[48:51]
  s_cbranch_vccnz L_tf_758
  s_cbranch_scc1 L_tm_759
  s_waitcnt vmcnt(3)
L_tm_759:
  s_waitcnt vmcnt(4)
L_tf_758:
  s_cbranch_scc1 L_te_760
  s_waitcnt vmcnt(5)
L_te_760:
  s_waitcnt vmcnt(7)
  s_mov_b64 exec, s[50:51]
  global_load_dwordx4 v[204:207], v19, s[10:11] offset:128 nt
  s_mov_b64 exec, -1
  v_mfma_f32_16x16x32_bf16 v[48:51], v[96:99], v[160:163], v[48:51]
  s_cbranch_vccnz L_tf_761
  s_cbranch_scc1 L_tm_762
  s_waitcnt vmcnt(3)
L_tm_762:
  s_waitcnt vmcnt(4)
L_tf_761:
  s_cbranch_scc1 L_te_763
  s_waitcnt vmcnt(5)
L_te_763:
  s_waitcnt vmcnt(7)
  s_mov_b64 exec, s[50:51]
  global_load_dwordx4 v[220:223], v19, s[10:11] offset:256 nt
  s_mov_b64 exec, -1
  v_mfma_f32_16x16x32_bf16 v[48:51], v[100:103], v[164:167], v[48:51]
  s_cbranch_vccnz L_tf_764
  s_cbranch_scc1 L_tm_765
  s_waitcnt vmcnt(3)
L_tm_765:
  s_waitcnt vmcnt(4)
L_tf_764:
  s_cbranch_scc1 L_te_766
  s_waitcnt vmcnt(5)
L_te_766:
  s_waitcnt vmcnt(7)
  s_mov_b64 exec, s[50:51]
  global_load_dwordx4 v[192:195], v19, s[10:11] offset:1152 nt
  s_mov_b64 exec, -1
  v_mfma_f32_16x16x32_bf16 v[48:51], v[104:107], v[168:171], v[48:51]
  s_cbranch_vccnz L_tf_767
  s_cbranch_scc1 L_tm_768
  s_waitcnt vmcnt(3)
L_tm_768:
  s_waitcnt vmcnt(4)
L_tf_767:
  s_cbranch_scc1 L_te_769
  s_waitcnt vmcnt(5)
L_te_769:
  s_waitcnt vmcnt(7)
  s_mov_b64 exec, s[50:51]
  global_load_dwordx4 v[208:211], v19, s[10:11] offset:1280 nt
  s_mov_b64 exec, -1
  v_mfma_f32_16x16x32_bf16 v[48:51], v[108:111], v[172:175], v[48:51]
  s_memrealtime s[58:59]
  ds_read_b64 v[252:253], v2 offset:3112
  s_cbranch_vccnz L_tf_770
  s_cbranch_scc1 L_tm_771
  s_waitcnt vmcnt(3)
L_tm_771:
  s_waitcnt vmcnt(4)
L_tf_770:
  s_cbranch_scc1 L_te_772
  s_waitcnt vmcnt(5)
L_te_772:
  s_waitcnt vmcnt(7)
  s_mov_b64 exec, s[50:51]
  global_load_dwordx4 v[224:227], v19, s[10:11] offset:1408 nt
  s_mov_b64 exec, -1
  v_mfma_f32_16x16x32_bf16 v[48:51], v[112:115], v[176:179], v[48:51]
  s_cbranch_vccnz L_tf_773
  s_cbranch_scc1 L_tm_774
  s_waitcnt vmcnt(3)
L_tm_774:
  s_waitcnt vmcnt(4)
L_tf_773:
  s_cbranch_scc1 L_te_775
  s_waitcnt vmcnt(5)
L_te_775:
  s_waitcnt vmcnt(7)
  s_mov_b64 exec, s[50:51]
  global_load_dwordx4 v[196:199], v19, s[10:11] offset:2304 nt
  s_mov_b64 exec, -1
  v_mfma_f32_16x16x32_bf16 v[48:51], v[116:119], v[180:183], v[48:51]
  s_waitcnt lgkmcnt(0)
  v_readfirstlane_b32 s54, v252
  v_readfirstlane_b32 s59, v253
  s_sub_u32 s57, s58, s54
  s_mul_i32 s33, s59, 35
  s_lshr_b32 s33, s33, 4
  s_cselect_b32 s57, s57, 0
  s_sub_u32 s57, s57, s33
  s_cmp_gt_i32 s57, 26
  s_cselect_b64 vcc, -1, 0
  s_cselect_b32 s33, s98, s99
  s_cmp_gt_i32 s57, s33
  s_cbranch_vccnz L_tf_776
  s_cbranch_scc1 L_tm_777
  s_waitcnt vmcnt(3)
L_tm_777:
  s_waitcnt vmcnt(4)
L_tf_776:
  s_cbranch_scc1 L_te_778
  s_waitcnt vmcnt(5)
L_te_778:
  s_waitcnt vmcnt(7)
  s_mov_b64 exec, s[50:51]
  global_load_dwordx4 v[212:215], v19, s[10:11] offset:2432 nt
  s_mov_b64 exec, -1
  v_mfma_f32_16x16x32_bf16 v[48:51], v[120:123], v[184:187], v[48:51]
  s_nop 7
  v_fma_f32 v36, v48, v14, v36
  v_fma_f32 v37, v49, v14, v37
  v_fma_f32 v38, v50, v14, v38
  v_fma_f32 v39, v51, v14, v39
  ds_write_b128 v15, v[36:39] offset:4096
  s_waitcnt lgkmcnt(0)
  s_barrier
  s_cmp_eq_u32 s30, 3
  s_cbranch_scc1 L_w3
  s_mov_b64 exec, s[50:51]
  global_load_dwordx4 v[228:231], v19, s[10:11] offset:2560 nt
  global_load_dwordx4 v[200:203], v19, s[10:11] offset:3456 nt
  global_load_dwordx4 v[216:219], v19, s[10:11] offset:3584 nt
  global_load_dwordx4 v[232:235], v19, s[10:11] offset:3712 nt
  s_mov_b64 exec, -1
  ds_read_b32 v244, v243 offset:3584
  ds_read_b32 v248, v243 offset:3616
  s_waitcnt lgkmcnt(0)
  s_waitcnt vmcnt(2)
  global_load_dwordx4 v[92:95], v241, s[46:47] sc1
  global_load_dwordx4 v[96:99], v241, s[46:47] offset:128 sc1
  s_mov_b32 s35, 524288
  s_waitcnt vmcnt(0)
L_l1_779:
  v_xor_b32 v92, v92, v236
  v_xor_b32 v93, v93, v237
  v_xor_b32 v94, v94, v238
  v_xor_b32 v95, v95, v239
  v_or_b32 v7, v92, v93
  v_or_b32 v8, v94, v95
  v_xor_b32 v96, v96, v236
  v_xor_b32 v97, v97, v237
  v_xor_b32 v98, v98, v238
  v_xor_b32 v99, v99, v239
  v_or3_b32 v7, v7, v96, v97
  v_or3_b32 v8, v8, v98, v99
  v_or_b32 v7, v7, v8
  v_and_b32 v7, 0xff, v7
  v_cmp_ne_u32 vcc, 0, v7
  s_cbranch_vccz L_l1d_780
  global_load_dwordx4 v[92:95], v241, s[46:47] sc1
  global_load_dwordx4 v[96:99], v241, s[46:47] offset:128 sc1
  s_waitcnt vmcnt(0)
  s_sub_u32 s35, s35, 1
  s_cbranch_scc0 L_l1_779
L_l1d_780:
  v_pk_mul_f32 v[92:93], v[92:93], v[244:245] op_sel_hi:[1,0]
  v_pk_mul_f32 v[94:95], v[94:95], v[244:245] op_sel_hi:[1,0]
  v_pk_fma_f32 v[92:93], v[96:97], v[248:249], v[92:93] op_sel_hi:[1,0,1]
  v_pk_fma_f32 v[94:95], v[98:99], v[248:249], v[94:95] op_sel_hi:[1,0,1]
  s_nop 0
  v_add_f32_dpp v92, v92, v92 quad_perm:[1,0,3,2] row_mask:0xf bank_mask:0xf
  v_add_f32_dpp v93, v93, v93 quad_perm:[1,0,3,2] row_mask:0xf bank_mask:0xf
  v_add_f32_dpp v94, v94, v94 quad_perm:[1,0,3,2] row_mask:0xf bank_mask:0xf
  v_add_f32_dpp v95, v95, v95 quad_perm:[1,0,3,2] row_mask:0xf bank_mask:0xf
  v_add_f32_dpp v92, v92, v92 quad_perm:[2,3,0,1] row_mask:0xf bank_mask:0xf
  v_add_f32_dpp v93, v93, v93 quad_perm:[2,3,0,1] row_mask:0xf bank_mask:0xf
  v_add_f32_dpp v94, v94, v94 quad_perm:[2,3,0,1] row_mask:0xf bank_mask:0xf
  v_add_f32_dpp v95, v95, v95 quad_perm:[2,3,0,1] row_mask:0xf bank_mask:0xf
  v_add_f32_dpp v92, v92, v92 row_half_mirror row_mask:0xf bank_mask:0xf
  v_add_f32_dpp v93, v93, v93 row_half_mirror row_mask:0xf bank_mask:0xf
  v_add_f32_dpp v94, v94, v94 row_half_mirror row_mask:0xf bank_mask:0xf
  v_add_f32_dpp v95, v95, v95 row_half_mirror row_mask:0xf bank_mask:0xf
  v_cvt_pk_bf16_f32 v56, v92, v93
  v_cvt_pk_bf16_f32 v57, v94, v95
  v_perm_b32 v100, v56, v56, v20
  v_perm_b32 v101, v56, v56, v21
  v_perm_b32 v102, v56, v56, v22
  v_perm_b32 v103, v56, v56, v23
  v_perm_b32 v104, v56, v56, v24
  v_perm_b32 v105, v56, v56, v25
  v_perm_b32 v106, v56, v56, v26
  v_perm_b32 v107, v56, v56, v27
  v_mfma_f32_16x16x32_bf16 v[124:127], v[100:103], v[188:191], 0
  v_mfma_f32_16x16x32_bf16 v[128:131], v[100:103], v[204:207], 0
  v_mfma_f32_16x16x32_bf16 v[132:135], v[100:103], v[220:223], 0
  v_perm_b32 v108, v57, v57, v20
  v_perm_b32 v109, v57, v57, v21
  v_perm_b32 v110, v57, v57, v22
  v_perm_b32 v111, v57, v57, v23
  v_mfma_f32_16x16x32_bf16 v[124:127], v[104:107], v[192:195], v[124:127]
  v_mfma_f32_16x16x32_bf16 v[128:131], v[104:107], v[208:211], v[128:131]
  v_mfma_f32_16x16x32_bf16 v[132:135], v[104:107], v[224:227], v[132:135]
  v_perm_b32 v112, v57, v57, v24
  v_perm_b32 v113, v57, v57, v25
  v_perm_b32 v114, v57, v57, v26
  v_perm_b32 v115, v57, v57, v27
  v_mfma_f32_16x16x32_bf16 v[124:127], v[108:111], v[196:199], v[124:127]
  v_mfma_f32_16x16x32_bf16 v[128:131], v[108:111], v[212:215], v[128:131]
  v_mfma_f32_16x16x32_bf16 v[132:135], v[108:111], v[228:231], v[132:135]
  v_mfma_f32_16x16x32_bf16 v[124:127], v[112:115], v[200:203], v[124:127]
  v_mfma_f32_16x16x32_bf16 v[128:131], v[112:115], v[216:219], v[128:131]
  v_mfma_f32_16x16x32_bf16 v[132:135], v[112:115], v[232:235], v[132:135]
  s_nop 6
  v_permlane32_swap_b32 v124, v128
  v_permlane32_swap_b32 v125, v129
  v_permlane32_swap_b32 v126, v130
  v_permlane32_swap_b32 v127, v131
  v_permlane32_swap_b32 v132, v136
  v_permlane32_swap_b32 v133, v137
  v_permlane32_swap_b32 v134, v138
  v_permlane32_swap_b32 v135, v139
  v_add_f32_dpp v140, v128, v124 row_ror:8 row_mask:0xf bank_mask:0x3
  v_add_f32_dpp v141, v129, v125 row_ror:8 row_mask:0xf bank_mask:0x3
  v_add_f32_dpp v142, v130, v126 row_ror:8 row_mask:0xf bank_mask:0x3
  v_add_f32_dpp v143, v131, v127 row_ror:8 row_mask:0xf bank_mask:0x3
  v_add_f32_dpp v140, v132, v136 row_ror:8 row_mask:0xf bank_mask:0xc
  v_add_f32_dpp v141, v133, v137 row_ror:8 row_mask:0xf bank_mask:0xc
  v_add_f32_dpp v142, v134, v138 row_ror:8 row_mask:0xf bank_mask:0xc
  v_add_f32_dpp v143, v135, v139 row_ror:8 row_mask:0xf bank_mask:0xc
  v_perm_b32 v140, v140, v240, s64
  v_perm_b32 v141, v141, v240, s65
  v_perm_b32 v142, v142, v240, s66
  v_perm_b32 v143, v143, v240, s67
  s_mov_b32 exec_hi, 0x00ff00ff
  global_store_dwordx4 v242, v[140:143], s[48:49] sc1
  s_waitcnt vmcnt(0)
  v_mov_b32 v8, 1
  s_mov_b64 exec, 1
  ds_add_u32 v2, v8 offset:3104
  s_mov_b64 exec, -1
L_sdone:
  s_endpgm

L_w3:
  ds_read_b128 v[92:95], v4 offset:8192
  ds_read_b128 v[96:99], v4 offset:9216
  ds_read_b128 v[100:103], v4 offset:10240
  ds_read_b128 v[104:107], v4 offset:11264
  s_waitcnt lgkmcnt(2)
  v_add_f32 v92, v92, v96
  v_add_f32 v93, v93, v97
  v_add_f32 v94, v94, v98
  v_add_f32 v95, v95, v99
  s_waitcnt lgkmcnt(0)
  v_add_f32 v100, v100, v104
  v_add_f32 v101, v101, v105
  v_add_f32 v102, v102, v106
  v_add_f32 v103, v103, v107
  v_add_f32 v92, v92, v100
  v_add_f32 v93, v93, v101
  v_add_f32 v94, v94, v102
  v_add_f32 v95, v95, v103
  v_perm_b32 v92, v92, v240, s64
  v_perm_b32 v93, v93, v240, s65
  v_perm_b32 v94, v94, v240, s66
  v_perm_b32 v95, v95, v240, s67
  s_cmp_eq_u32 s61, 1
  s_cbranch_scc1 L_gs_781
  global_store_dwordx4 v242, v[92:95], s[48:49] sc1
  s_branch L_gsj_782
L_gs_781:
  global_store_dwordx4 v242, v[92:95], s[48:49]
L_gsj_782:
  s_endpgm
.p2align 6
L_comm:
  s_setprio 3
  s_memrealtime s[56:57]
  s_mov_b32 s3, s2
  s_lshl_b32 s2, s31, 4
  s_or_b32 s2, s2, s32
  v_lshlrev_b32 v2, 2, v1
  v_mov_b32 v3, 0
  ds_write_b32 v2, v3 offset:3072
  v_mov_b32 v2, 0
  v_lshlrev_b32 v3, 4, v1
  s_getpc_b64 s[36:37]
L_pc0:
  s_sub_u32 s36, s36, L_pc0-concat_heads__gqa_block_cached__sliding_block_cached__decode_kernel
  s_subb_u32 s37, s37, 0
  s_lshr_b32 s33, s3, 3
  s_mulk_i32 s33, 1280
  v_lshl_add_u32 v5, v1, 7, s33
  v_min_u32 v5, L_end-concat_heads__gqa_block_cached__sliding_block_cached__decode_kernel, v5
  s_mov_b64 exec, 0x3ff
  v_mov_b32 v15, s37
  v_add_co_u32 v14, vcc, s36, v5
  s_nop 1
  v_addc_co_u32 v15, vcc, 0, v15, vcc
  global_load_dword v8, v[14:15], off
  s_cmp_ge_u32 s32, 8
  s_waitcnt lgkmcnt(0)
  s_cselect_b64 s[12:13], s[22:23], s[12:13]
  s_mov_b64 exec, 1
  s_cmp_lg_u32 s3, 0
  s_cbranch_scc1 L_nolead
  s_lshr_b64 s[56:57], s[56:57], 8
  s_mul_i32 s33, s56, 0x9e3779b1
  s_mul_i32 s34, s56, 0x85ebca6b
  s_add_u32 s34, s34, s57
  s_and_b32 s35, s33, 0x7f
  s_lshr_b32 s33, s33, 7
  s_lshl_b32 s33, s33, 9
  s_lshl_b32 s35, s35, 1
  s_or_b32 s33, s33, s35
  s_or_b32 s33, s33, 1
  s_and_b32 s35, s34, 0x7f
  s_lshr_b32 s34, s34, 7
  s_lshl_b32 s34, s34, 9
  s_lshl_b32 s35, s35, 1
  s_or_b32 s34, s34, s35
  s_or_b32 s34, s34, 1
  v_mov_b32 v16, s33
  v_mov_b32 v17, s34
  v_mov_b32 v18, 0
  v_mov_b32 v19, 0
  global_atomic_cmpswap_x2 v2, v[16:19], s[26:27] sc1
L_nolead:
  s_barrier
  s_mov_b32 s35, 524288
L_gf_783:
  global_load_dwordx2 v[10:11], v2, s[26:27] sc1
  s_waitcnt vmcnt(0)
  v_readfirstlane_b32 s62, v10
  v_readfirstlane_b32 s63, v11
  s_and_b32 s34, s62, s63
  s_bitcmp1_b32 s34, 0
  s_cbranch_scc1 L_gfd_784
  s_sub_u32 s35, s35, 1
  s_cbranch_scc0 L_gf_783
L_gfd_784:
  s_mov_b64 exec, -1
  v_mov_b32 v24, s62
  v_mov_b32 v25, s63
  ds_write_b64 v2, v[24:25] offset:3096
  s_mov_b32 s64, 0x07060500
  s_mov_b32 s65, 0x07060501
  s_mov_b32 s66, 0x07060502
  s_mov_b32 s67, 0x07060503
  v_and_b32 v4, 1, v1
  v_cmp_ne_u32 vcc, 0, v4
  v_mov_b32 v100, s62
  v_mov_b32 v4, s63
  v_cndmask_b32 v100, v100, v4, vcc
  v_bfe_u32 v63, v100, 24, 8
  v_bfe_u32 v62, v100, 16, 8
  v_bfe_u32 v61, v100, 8, 8
  v_bfe_u32 v60, v100, 0, 8
  s_lshl_b32 s33, s31, 12
  s_add_u32 s33, s33, 0x0
  s_add_u32 s36, s28, s33
  s_addc_u32 s37, s29, 0
  s_lshl_b32 s33, s32, 8
  s_add_u32 s38, s36, s33
  s_addc_u32 s39, s37, 0
  s_getreg_b32 s60, hwreg(HW_REG_XCC_ID, 0, 4)
  s_lshl_b32 s33, s60, 24
  v_xor_b32 v103, s33, v100
  s_mov_b32 s35, 8388608
L_lw_785:
  ds_read_b32 v4, v2 offset:3072
  s_waitcnt lgkmcnt(0)
  v_readfirstlane_b32 s34, v4
  s_cmp_eq_u32 s34, 4
  s_cbranch_scc1 L_lwd_786
  s_sub_u32 s35, s35, 1
  s_cbranch_scc0 L_lw_785
L_lwd_786:
  s_mov_b64 exec, 0xffff
  ds_read_b128 v[24:27], v3 offset:0
  ds_read_b128 v[28:31], v3 offset:256
  ds_read_b128 v[32:35], v3 offset:512
  ds_read_b128 v[36:39], v3 offset:768
  ds_read_b128 v[40:43], v3 offset:1024
  ds_read_b128 v[44:47], v3 offset:1280
  ds_read_b128 v[48:51], v3 offset:1536
  ds_read_b128 v[52:55], v3 offset:1792
  s_waitcnt lgkmcnt(0)
  v_add_f32 v24, v24, v40
  v_add_f32 v25, v25, v41
  v_add_f32 v26, v26, v42
  v_add_f32 v27, v27, v43
  v_add_f32 v28, v28, v44
  v_add_f32 v29, v29, v45
  v_add_f32 v30, v30, v46
  v_add_f32 v31, v31, v47
  v_add_f32 v32, v32, v48
  v_add_f32 v33, v33, v49
  v_add_f32 v34, v34, v50
  v_add_f32 v35, v35, v51
  v_add_f32 v36, v36, v52
  v_add_f32 v37, v37, v53
  v_add_f32 v38, v38, v54
  v_add_f32 v39, v39, v55
  v_add_f32 v24, v24, v32
  v_add_f32 v25, v25, v33
  v_add_f32 v26, v26, v34
  v_add_f32 v27, v27, v35
  v_add_f32 v28, v28, v36
  v_add_f32 v29, v29, v37
  v_add_f32 v30, v30, v38
  v_add_f32 v31, v31, v39
  v_add_f32 v24, v24, v28
  v_add_f32 v25, v25, v29
  v_add_f32 v26, v26, v30
  v_add_f32 v27, v27, v31
  v_perm_b32 v24, v24, v103, s64
  v_perm_b32 v25, v25, v103, s65
  v_perm_b32 v26, v26, v103, s66
  v_perm_b32 v27, v27, v103, s67
  global_store_dwordx4 v3, v[24:27], s[38:39] sc1
  s_mov_b64 exec, -1
  s_mov_b32 s35, 8388608
L_lw_787:
  ds_read_b32 v4, v2 offset:3080
  s_waitcnt lgkmcnt(0)
  v_readfirstlane_b32 s34, v4
  s_cmp_ge_u32 s34, 1
  s_cbranch_scc1 L_lwd_788
  s_sleep 1
  s_sub_u32 s35, s35, 1
  s_cbranch_scc0 L_lw_787
L_lwd_788:
  s_mov_b32 s35, 524288
L_qp_789:
  global_load_dwordx4 v[64:67], v3, s[36:37] offset:0 sc1
  global_load_dwordx4 v[68:71], v3, s[36:37] offset:1024 sc1
  global_load_dwordx4 v[72:75], v3, s[36:37] offset:2048 sc1
  global_load_dwordx4 v[76:79], v3, s[36:37] offset:3072 sc1
  s_waitcnt vmcnt(0)
  v_xor_b32 v64, v64, v60
  v_xor_b32 v65, v65, v61
  v_xor_b32 v66, v66, v62
  v_xor_b32 v67, v67, v63
  v_xor_b32 v68, v68, v60
  v_xor_b32 v69, v69, v61
  v_xor_b32 v70, v70, v62
  v_xor_b32 v71, v71, v63
  v_xor_b32 v72, v72, v60
  v_xor_b32 v73, v73, v61
  v_xor_b32 v74, v74, v62
  v_xor_b32 v75, v75, v63
  v_xor_b32 v76, v76, v60
  v_xor_b32 v77, v77, v61
  v_xor_b32 v78, v78, v62
  v_xor_b32 v79, v79, v63
  v_or3_b32 v5, v67, v71, v75
  v_or_b32 v5, v5, v79
  v_and_b32 v4, 0xf0, v5
  v_or3_b32 v4, v4, v64, v65
  v_or_b32 v4, v4, v66
  v_or3_b32 v4, v4, v68, v69
  v_or_b32 v4, v4, v70
  v_or3_b32 v4, v4, v72, v73
  v_or_b32 v4, v4, v74
  v_or3_b32 v4, v4, v76, v77
  v_or_b32 v4, v4, v78
  v_and_b32 v4, 0xff, v4
  v_cmp_ne_u32 vcc, 0, v4
  s_cbranch_vccz L_qd_790
  s_sub_u32 s35, s35, 1
  s_cbranch_scc0 L_qp_789
L_qd_790:
  v_xor_b32 v80, s60, v67
  v_bitop3_b32 v80, v80, v71, s60 bitop3:0xf6
  v_bitop3_b32 v80, v80, v75, s60 bitop3:0xf6
  v_bitop3_b32 v80, v80, v79, s60 bitop3:0xf6
  v_and_b32 v67, -16, v67
  v_and_b32 v71, -16, v71
  v_and_b32 v75, -16, v75
  v_and_b32 v79, -16, v79
  v_add_f32 v8, v64, v68
  v_add_f32 v9, v65, v69
  v_add_f32 v10, v66, v70
  v_add_f32 v11, v67, v71
  v_add_f32 v12, v72, v76
  v_add_f32 v13, v73, v77
  v_add_f32 v14, v74, v78
  v_add_f32 v15, v75, v79
  v_lshlrev_b32 v7, 3, v1
  v_mov_b32 v5, 1
  v_cvt_pk_bf16_f32 v16, v8, v9
  v_cvt_pk_bf16_f32 v17, v10, v11
  v_cvt_pk_bf16_f32 v18, v12, v13
  v_cvt_pk_bf16_f32 v19, v14, v15
  ds_write_b64 v7, v[16:17] offset:2048
  ds_write_b64 v7, v[18:19] offset:2560
  ds_write_b32 v2, v5 offset:3076
  v_and_b32 v80, 15, v80
  v_cmp_ne_u32 vcc, 0, v80
  s_nop 1
  s_cmp_eq_u64 vcc, 0
  s_cselect_b32 s61, 1, 0
  v_mov_b32 v5, s61
  ds_write_b32 v2, v5 offset:3108
  v_and_b32 v4, 1, v1
  v_bfe_u32 v5, v1, 1, 1
  v_lshlrev_b32 v4, 4, v4
  v_lshl_add_u32 v28, v5, 3, v4
  v_lshl_add_u32 v29, v5, 2, v4
  s_lshl_b32 s33, s2, 7
  s_add_u32 s33, s33, 0x10000
  s_add_u32 s38, s28, s33
  s_addc_u32 s39, s29, 0
  v_lshlrev_b32 v6, 8, v1
  s_lshl_b32 s33, s31, 15
  s_lshl_b32 s34, s32, 4
  s_add_u32 s33, s33, s34
  s_add_u32 s33, s33, 0x40000
  s_add_u32 s36, s28, s33
  s_addc_u32 s37, s29, 0
  s_bitcmp1_b32 s32, 0
  s_cselect_b32 s33, s63, s62
  v_mov_b32 v100, s33
  s_lshl_b32 s33, s3, 13
  s_add_u32 s33, s33, 0xc1000
  s_add_u32 s40, s28, s33
  s_addc_u32 s41, s29, 0
  s_add_u32 s44, s40, 8192
  s_addc_u32 s45, s41, 0
  s_lshr_b32 s33, s3, 1
  s_lshl_b32 s33, s33, 6
  s_and_b32 s34, s3, 1
  s_lshl_b32 s34, s34, 3
  s_add_u32 s33, s33, s34
  s_add_u32 s24, s24, s33
  s_addc_u32 s25, s25, 0
  v_mov_b32 v7, v3
  v_and_b32 v7, 48, v3
  v_lshrrev_b32 v4, 4, v1
  v_lshl_add_u32 v7, v4, 1, v7
  s_setprio 0
  s_mov_b32 s35, 8388608
L_lw_791:
  ds_read_b32 v4, v2 offset:3120
  s_waitcnt lgkmcnt(0)
  v_readfirstlane_b32 s34, v4
  s_cmp_ge_u32 s34, 1
  s_cbranch_scc1 L_lwd_792
  s_sleep 4
  s_sub_u32 s35, s35, 1
  s_cbranch_scc0 L_lw_791
L_lwd_792:
  s_load_dword s4, s[28:29], 0x24000
  s_load_dword s5, s[28:29], 0x24100
  s_load_dword s6, s[28:29], 0x24200
  s_load_dword s7, s[28:29], 0x24300
  s_load_dword s8, s[28:29], 0x24400
  s_load_dword s9, s[28:29], 0x24500
  s_load_dword s10, s[28:29], 0x24600
  s_load_dword s11, s[28:29], 0x24700
  s_memrealtime s[58:59]
  s_waitcnt lgkmcnt(0)
  s_add_u32 s20, s58, s62
  s_mov_b32 s21, 212
  s_mov_b32 s22, 0
  s_sub_u32 s33, s20, s4
  s_cmp_lt_u32 s33, 2048
  s_cselect_b32 s21, s33, s21
  s_add_u32 s22, s22, s21
  s_sub_u32 s33, s20, s5
  s_cmp_lt_u32 s33, 2048
  s_cselect_b32 s21, s33, s21
  s_add_u32 s22, s22, s21
  s_sub_u32 s33, s20, s6
  s_cmp_lt_u32 s33, 2048
  s_cselect_b32 s21, s33, s21
  s_add_u32 s22, s22, s21
  s_sub_u32 s33, s20, s7
  s_cmp_lt_u32 s33, 2048
  s_cselect_b32 s21, s33, s21
  s_add_u32 s22, s22, s21
  s_sub_u32 s33, s20, s8
  s_cmp_lt_u32 s33, 2048
  s_cselect_b32 s21, s33, s21
  s_add_u32 s22, s22, s21
  s_sub_u32 s33, s20, s9
  s_cmp_lt_u32 s33, 2048
  s_cselect_b32 s21, s33, s21
  s_add_u32 s22, s22, s21
  s_sub_u32 s33, s20, s10
  s_cmp_lt_u32 s33, 2048
  s_cselect_b32 s21, s33, s21
  s_add_u32 s22, s22, s21
  s_sub_u32 s33, s20, s11
  s_cmp_lt_u32 s33, 2048
  s_cselect_b32 s21, s33, s21
  s_add_u32 s22, s22, s21
  s_lshr_b32 s22, s22, 3
  s_sub_u32 s22, s58, s22
  s_mov_b32 s21, 1700
  s_mov_b32 s23, s22
  s_mul_i32 s33, s21, 5
  s_lshr_b32 s33, s33, 4
  s_sub_u32 s22, s22, s33
  v_mov_b32 v104, s22
  v_mov_b32 v105, s21
  ds_write_b64 v2, v[104:105] offset:3112
  s_mov_b32 s35, 8388608
L_lw_793:
  ds_read_b32 v4, v2 offset:3120
  s_waitcnt lgkmcnt(0)
  v_readfirstlane_b32 s34, v4
  s_cmp_ge_u32 s34, 5
  s_cbranch_scc1 L_lwd_794
  s_sleep 4
  s_sub_u32 s35, s35, 1
  s_cbranch_scc0 L_lw_793
L_lwd_794:
  s_load_dword s4, s[28:29], 0x25100
  s_load_dword s5, s[28:29], 0x25200
  s_load_dword s6, s[28:29], 0x25300
  s_load_dword s7, s[28:29], 0x25400
  s_load_dword s8, s[28:29], 0x25500
  s_load_dword s9, s[28:29], 0x25600
  s_load_dword s10, s[28:29], 0x25700
  s_load_dword s11, s[28:29], 0x25800
  s_memrealtime s[58:59]
  s_waitcnt lgkmcnt(0)
  s_add_u32 s20, s58, s62
  s_mov_b32 s21, 212
  s_mov_b32 s22, 0
  s_sub_u32 s33, s20, s4
  s_cmp_lt_u32 s33, 2048
  s_cselect_b32 s21, s33, s21
  s_add_u32 s22, s22, s21
  s_sub_u32 s33, s20, s5
  s_cmp_lt_u32 s33, 2048
  s_cselect_b32 s21, s33, s21
  s_add_u32 s22, s22, s21
  s_sub_u32 s33, s20, s6
  s_cmp_lt_u32 s33, 2048
  s_cselect_b32 s21, s33, s21
  s_add_u32 s22, s22, s21
  s_sub_u32 s33, s20, s7
  s_cmp_lt_u32 s33, 2048
  s_cselect_b32 s21, s33, s21
  s_add_u32 s22, s22, s21
  s_sub_u32 s33, s20, s8
  s_cmp_lt_u32 s33, 2048
  s_cselect_b32 s21, s33, s21
  s_add_u32 s22, s22, s21
  s_sub_u32 s33, s20, s9
  s_cmp_lt_u32 s33, 2048
  s_cselect_b32 s21, s33, s21
  s_add_u32 s22, s22, s21
  s_sub_u32 s33, s20, s10
  s_cmp_lt_u32 s33, 2048
  s_cselect_b32 s21, s33, s21
  s_add_u32 s22, s22, s21
  s_sub_u32 s33, s20, s11
  s_cmp_lt_u32 s33, 2048
  s_cselect_b32 s21, s33, s21
  s_add_u32 s22, s22, s21
  s_lshr_b32 s22, s22, 3
  s_sub_u32 s22, s58, s22
  s_mov_b32 s21, 1700
  s_sub_u32 s33, s22, s23
  s_mul_i32 s33, s33, 1024
  s_lshr_b32 s33, s33, 8
  s_sub_u32 s33, s33, 32
  s_max_i32 s21, s21, s33
  s_min_i32 s21, s21, 3401
  s_mov_b32 s23, s22
  s_mul_i32 s33, s21, 9
  s_lshr_b32 s33, s33, 4
  s_sub_u32 s22, s22, s33
  v_mov_b32 v104, s22
  v_mov_b32 v105, s21
  ds_write_b64 v2, v[104:105] offset:3112
  s_mov_b32 s35, 8388608
L_lw_795:
  ds_read_b32 v4, v2 offset:3120
  s_waitcnt lgkmcnt(0)
  v_readfirstlane_b32 s34, v4
  s_cmp_ge_u32 s34, 9
  s_cbranch_scc1 L_lwd_796
  s_sleep 4
  s_sub_u32 s35, s35, 1
  s_cbranch_scc0 L_lw_795
L_lwd_796:
  s_load_dword s4, s[28:29], 0x26200
  s_load_dword s5, s[28:29], 0x26300
  s_load_dword s6, s[28:29], 0x26400
  s_load_dword s7, s[28:29], 0x26500
  s_load_dword s8, s[28:29], 0x26600
  s_load_dword s9, s[28:29], 0x26700
  s_load_dword s10, s[28:29], 0x26800
  s_load_dword s11, s[28:29], 0x26900
  s_memrealtime s[58:59]
  s_waitcnt lgkmcnt(0)
  s_add_u32 s20, s58, s62
  s_mov_b32 s21, 212
  s_mov_b32 s22, 0
  s_sub_u32 s33, s20, s4
  s_cmp_lt_u32 s33, 2048
  s_cselect_b32 s21, s33, s21
  s_add_u32 s22, s22, s21
  s_sub_u32 s33, s20, s5
  s_cmp_lt_u32 s33, 2048
  s_cselect_b32 s21, s33, s21
  s_add_u32 s22, s22, s21
  s_sub_u32 s33, s20, s6
  s_cmp_lt_u32 s33, 2048
  s_cselect_b32 s21, s33, s21
  s_add_u32 s22, s22, s21
  s_sub_u32 s33, s20, s7
  s_cmp_lt_u32 s33, 2048
  s_cselect_b32 s21, s33, s21
  s_add_u32 s22, s22, s21
  s_sub_u32 s33, s20, s8
  s_cmp_lt_u32 s33, 2048
  s_cselect_b32 s21, s33, s21
  s_add_u32 s22, s22, s21
  s_sub_u32 s33, s20, s9
  s_cmp_lt_u32 s33, 2048
  s_cselect_b32 s21, s33, s21
  s_add_u32 s22, s22, s21
  s_sub_u32 s33, s20, s10
  s_cmp_lt_u32 s33, 2048
  s_cselect_b32 s21, s33, s21
  s_add_u32 s22, s22, s21
  s_sub_u32 s33, s20, s11
  s_cmp_lt_u32 s33, 2048
  s_cselect_b32 s21, s33, s21
  s_add_u32 s22, s22, s21
  s_lshr_b32 s22, s22, 3
  s_sub_u32 s22, s58, s22
  s_mov_b32 s21, 1700
  s_sub_u32 s33, s22, s23
  s_mul_i32 s33, s33, 682
  s_lshr_b32 s33, s33, 8
  s_sub_u32 s33, s33, 32
  s_max_i32 s21, s21, s33
  s_min_i32 s21, s21, 3401
  s_mov_b32 s23, s22
  s_mul_i32 s33, s21, 15
  s_lshr_b32 s33, s33, 4
  s_sub_u32 s22, s22, s33
  v_mov_b32 v104, s22
  v_mov_b32 v105, s21
  ds_write_b64 v2, v[104:105] offset:3112
  s_mov_b32 s35, 8388608
L_lw_797:
  ds_read_b32 v4, v2 offset:3120
  s_waitcnt lgkmcnt(0)
  v_readfirstlane_b32 s34, v4
  s_cmp_ge_u32 s34, 13
  s_cbranch_scc1 L_lwd_798
  s_sleep 4
  s_sub_u32 s35, s35, 1
  s_cbranch_scc0 L_lw_797
L_lwd_798:
  s_load_dword s4, s[28:29], 0x27300
  s_load_dword s5, s[28:29], 0x27400
  s_load_dword s6, s[28:29], 0x27500
  s_load_dword s7, s[28:29], 0x27600
  s_load_dword s8, s[28:29], 0x27700
  s_load_dword s9, s[28:29], 0x27800
  s_load_dword s10, s[28:29], 0x27900
  s_load_dword s11, s[28:29], 0x27a00
  s_memrealtime s[58:59]
  s_waitcnt lgkmcnt(0)
  s_add_u32 s20, s58, s62
  s_mov_b32 s21, 212
  s_mov_b32 s22, 0
  s_sub_u32 s33, s20, s4
  s_cmp_lt_u32 s33, 2048
  s_cselect_b32 s21, s33, s21
  s_add_u32 s22, s22, s21
  s_sub_u32 s33, s20, s5
  s_cmp_lt_u32 s33, 2048
  s_cselect_b32 s21, s33, s21
  s_add_u32 s22, s22, s21
  s_sub_u32 s33, s20, s6
  s_cmp_lt_u32 s33, 2048
  s_cselect_b32 s21, s33, s21
  s_add_u32 s22, s22, s21
  s_sub_u32 s33, s20, s7
  s_cmp_lt_u32 s33, 2048
  s_cselect_b32 s21, s33, s21
  s_add_u32 s22, s22, s21
  s_sub_u32 s33, s20, s8
  s_cmp_lt_u32 s33, 2048
  s_cselect_b32 s21, s33, s21
  s_add_u32 s22, s22, s21
  s_sub_u32 s33, s20, s9
  s_cmp_lt_u32 s33, 2048
  s_cselect_b32 s21, s33, s21
  s_add_u32 s22, s22, s21
  s_sub_u32 s33, s20, s10
  s_cmp_lt_u32 s33, 2048
  s_cselect_b32 s21, s33, s21
  s_add_u32 s22, s22, s21
  s_sub_u32 s33, s20, s11
  s_cmp_lt_u32 s33, 2048
  s_cselect_b32 s21, s33, s21
  s_add_u32 s22, s22, s21
  s_lshr_b32 s22, s22, 3
  s_sub_u32 s22, s58, s22
  s_mov_b32 s21, 1700
  s_sub_u32 s33, s22, s23
  s_mul_i32 s33, s33, 682
  s_lshr_b32 s33, s33, 8
  s_sub_u32 s33, s33, 32
  s_max_i32 s21, s21, s33
  s_min_i32 s21, s21, 3401
  s_mov_b32 s23, s22
  s_mul_i32 s33, s21, 21
  s_lshr_b32 s33, s33, 4
  s_sub_u32 s22, s22, s33
  v_mov_b32 v104, s22
  v_mov_b32 v105, s21
  ds_write_b64 v2, v[104:105] offset:3112
  s_mov_b32 s35, 8388608
L_lw_799:
  ds_read_b32 v4, v2 offset:3084
  s_waitcnt lgkmcnt(0)
  v_readfirstlane_b32 s34, v4
  s_cmp_ge_u32 s34, 1
  s_cbranch_scc1 L_lwd_800
  s_sleep 8
  s_sub_u32 s35, s35, 1
  s_cbranch_scc0 L_lw_799
L_lwd_800:
  s_mov_b64 exec, 0xffff
  s_lshl_b32 s33, s2, 11
  s_add_u32 s33, s33, 0x40000
  v_lshl_add_u32 v4, v1, 7, s33
  s_lshl_b32 s33, s2, 7
  s_add_u32 s33, s33, 0x10000
  v_writelane_b32 v4, s33, 16
  s_mov_b64 exec, 0x1ffff
  global_load_dword v53, v4, s[28:29] sc1
  s_mov_b64 exec, -1
  s_waitcnt vmcnt(0)
  s_mov_b32 s35, 8388608
L_lw_801:
  ds_read_b32 v4, v2 offset:3088
  s_waitcnt lgkmcnt(0)
  v_readfirstlane_b32 s34, v4
  s_cmp_eq_u32 s34, 4
  s_cbranch_scc1 L_lwd_802
  s_sleep 1
  s_sub_u32 s35, s35, 1
  s_cbranch_scc0 L_lw_801
L_lwd_802:
  ds_read_b64 v[8:9], v28 offset:3392
  ds_read_b64 v[10:11], v28 offset:3424
  ds_read_b64 v[12:13], v28 offset:3456
  ds_read_b64 v[14:15], v28 offset:3488
  s_waitcnt lgkmcnt(0)
  v_max3_f32 v56, v8, v10, v12
  v_max_f32 v56, v56, v14
  v_sub_f32 v8, v8, v56
  v_sub_f32 v10, v10, v56
  v_sub_f32 v12, v12, v56
  v_sub_f32 v14, v14, v56
  v_exp_f32 v8, v8
  v_exp_f32 v10, v10
  v_exp_f32 v12, v12
  v_exp_f32 v14, v14
  v_mul_f32 v58, v8, v9
  v_fma_f32 v58, v10, v11, v58
  v_fma_f32 v58, v12, v13, v58
  v_fma_f32 v58, v14, v15, v58
  v_mov_b32 v57, s62
  v_mov_b32 v59, s63
  v_mov_b32 v5, 1
  ds_write_b32 v29, v56 offset:3328
  ds_write_b32 v2, v5 offset:3092
  s_mov_b64 exec, 0xff
  s_cmp_eq_u32 s61, 1
  s_cbranch_scc1 L_gs_803
  global_store_dwordx4 v3, v[56:59], s[38:39] sc1
  s_branch L_gsj_804
L_gs_803:
  global_store_dwordx4 v3, v[56:59], s[38:39]
L_gsj_804:
  s_mov_b64 exec, -1
  s_mov_b32 s35, 8388608
L_lw_805:
  ds_read_b32 v4, v2 offset:3120
  s_waitcnt lgkmcnt(0)
  v_readfirstlane_b32 s34, v4
  s_cmp_ge_u32 s34, 17
  s_cbranch_scc1 L_lwd_806
  s_sleep 4
  s_sub_u32 s35, s35, 1
  s_cbranch_scc0 L_lw_805
L_lwd_806:
  s_load_dword s4, s[28:29], 0x28400
  s_load_dword s5, s[28:29], 0x28500
  s_load_dword s6, s[28:29], 0x28600
  s_load_dword s7, s[28:29], 0x28700
  s_load_dword s8, s[28:29], 0x28800
  s_load_dword s9, s[28:29], 0x28900
  s_load_dword s10, s[28:29], 0x28a00
  s_load_dword s11, s[28:29], 0x28b00
  s_memrealtime s[58:59]
  s_waitcnt lgkmcnt(0)
  s_add_u32 s20, s58, s62
  s_mov_b32 s21, 212
  s_mov_b32 s22, 0
  s_sub_u32 s33, s20, s4
  s_cmp_lt_u32 s33, 2048
  s_cselect_b32 s21, s33, s21
  s_add_u32 s22, s22, s21
  s_sub_u32 s33, s20, s5
  s_cmp_lt_u32 s33, 2048
  s_cselect_b32 s21, s33, s21
  s_add_u32 s22, s22, s21
  s_sub_u32 s33, s20, s6
  s_cmp_lt_u32 s33, 2048
  s_cselect_b32 s21, s33, s21
  s_add_u32 s22, s22, s21
  s_sub_u32 s33, s20, s7
  s_cmp_lt_u32 s33, 2048
  s_cselect_b32 s21, s33, s21
  s_add_u32 s22, s22, s21
  s_sub_u32 s33, s20, s8
  s_cmp_lt_u32 s33, 2048
  s_cselect_b32 s21, s33, s21
  s_add_u32 s22, s22, s21
  s_sub_u32 s33, s20, s9
  s_cmp_lt_u32 s33, 2048
  s_cselect_b32 s21, s33, s21
  s_add_u32 s22, s22, s21
  s_sub_u32 s33, s20, s10
  s_cmp_lt_u32 s33, 2048
  s_cselect_b32 s21, s33, s21
  s_add_u32 s22, s22, s21
  s_sub_u32 s33, s20, s11
  s_cmp_lt_u32 s33, 2048
  s_cselect_b32 s21, s33, s21
  s_add_u32 s22, s22, s21
  s_lshr_b32 s22, s22, 3
  s_sub_u32 s22, s58, s22
  s_mov_b32 s21, 1700
  s_sub_u32 s33, s22, s23
  s_mul_i32 s33, s33, 585
  s_lshr_b32 s33, s33, 8
  s_sub_u32 s33, s33, 32
  s_max_i32 s21, s21, s33
  s_min_i32 s21, s21, 3401
  s_mov_b32 s23, s22
  s_mul_i32 s33, s21, 28
  s_lshr_b32 s33, s33, 4
  s_sub_u32 s22, s22, s33
  v_mov_b32 v104, s22
  v_mov_b32 v105, s21
  ds_write_b64 v2, v[104:105] offset:3112
  v_and_b32 v110, 7, v1
  v_lshlrev_b32 v111, 2, v110
  v_lshlrev_b32 v110, 7, v110
  s_lshl_b32 s34, s31, 11
  s_lshr_b32 s35, s32, 2
  s_lshl_b32 s35, s35, 4
  s_add_u32 s34, s34, s35
  s_add_u32 s34, s34, 0x10000
  s_add_u32 s52, s28, s34
  s_addc_u32 s53, s29, 0
  s_mov_b64 exec, 0xffff
  global_load_dwordx4 v[112:115], v110, s[52:53] sc1
  global_load_dwordx4 v[116:119], v110, s[52:53] offset:1024 sc1
  s_waitcnt vmcnt(0)
  s_mov_b32 s35, 524288
L_g1_807:
  v_xor_b32 v4, s62, v113
  v_xor_b32 v5, s63, v115
  v_bitop3_b32 v4, v4, v117, s62 bitop3:0xf6
  v_bitop3_b32 v5, v5, v119, s63 bitop3:0xf6
  v_or_b32 v4, v4, v5
  v_cmp_ne_u32 vcc, 0, v4
  s_cbranch_vccz L_g1d_808
  global_load_dwordx4 v[112:115], v110, s[52:53] sc1
  global_load_dwordx4 v[116:119], v110, s[52:53] offset:1024 sc1
  s_waitcnt vmcnt(0)
  s_sub_u32 s35, s35, 1
  s_cbranch_scc0 L_g1_807
L_g1d_808:
  v_max_f32 v4, v112, v116
  s_nop 1
  v_max_f32_dpp v4, v4, v4 quad_perm:[1,0,3,2] row_mask:0xf bank_mask:0xf
  s_nop 1
  v_max_f32_dpp v4, v4, v4 quad_perm:[2,3,0,1] row_mask:0xf bank_mask:0xf
  s_nop 1
  v_max_f32_dpp v4, v4, v4 row_half_mirror row_mask:0xf bank_mask:0xf
  v_sub_f32 v112, v112, v4
  v_sub_f32 v116, v116, v4
  v_exp_f32 v112, v112
  v_exp_f32 v116, v116
  v_mul_f32 v4, v112, v114
  v_fma_f32 v4, v116, v118, v4
  s_nop 1
  v_add_f32_dpp v4, v4, v4 quad_perm:[1,0,3,2] row_mask:0xf bank_mask:0xf
  s_nop 1
  v_add_f32_dpp v4, v4, v4 quad_perm:[2,3,0,1] row_mask:0xf bank_mask:0xf
  s_nop 1
  v_add_f32_dpp v4, v4, v4 row_half_mirror row_mask:0xf bank_mask:0xf
  v_rcp_f32 v4, v4
  s_nop 0
  v_mul_f32 v112, v112, v4
  v_mul_f32 v116, v116, v4
  ds_write_b32 v111, v112 offset:3584
  ds_write_b32 v111, v116 offset:3616
  s_mov_b64 exec, -1
  s_setprio 3
  s_waitcnt lgkmcnt(0)
  s_barrier
  ds_read_b128 v[8:11], v3 offset:4096
  ds_read_b128 v[12:15], v3 offset:5120
  ds_read_b128 v[16:19], v3 offset:6144
  ds_read_b128 v[20:23], v3 offset:7168
  s_waitcnt lgkmcnt(2)
  v_add_f32 v8, v8, v12
  v_add_f32 v9, v9, v13
  v_add_f32 v10, v10, v14
  v_add_f32 v11, v11, v15
  s_waitcnt lgkmcnt(0)
  v_add_f32 v16, v16, v20
  v_add_f32 v17, v17, v21
  v_add_f32 v18, v18, v22
  v_add_f32 v19, v19, v23
  v_add_f32 v8, v8, v16
  v_add_f32 v9, v9, v17
  v_add_f32 v10, v10, v18
  v_add_f32 v11, v11, v19
  v_perm_b32 v8, v8, v100, s64
  v_perm_b32 v9, v9, v100, s65
  v_perm_b32 v10, v10, v100, s66
  v_perm_b32 v11, v11, v100, s67
  s_cmp_eq_u32 s61, 1
  s_cbranch_scc1 L_gs_809
  global_store_dwordx4 v6, v[8:11], s[36:37] sc1
  s_branch L_gsj_810
L_gs_809:
  global_store_dwordx4 v6, v[8:11], s[36:37]
L_gsj_810:
  s_cmp_ge_u32 s3, 72
  s_cbranch_scc1 L_cdone
  s_mov_b32 s35, 8388608
L_lw_811:
  ds_read_b32 v4, v2 offset:3104
  s_waitcnt lgkmcnt(0)
  v_readfirstlane_b32 s34, v4
  s_cmp_ge_u32 s34, 3
  s_cbranch_scc1 L_lwd_812
  s_sub_u32 s35, s35, 1
  s_cbranch_scc0 L_lw_811
L_lwd_812:
  s_mov_b32 s35, 524288
L_l2_813:
  global_load_dwordx4 v[128:131], v3, s[40:41] offset:-4096 sc1
  global_load_dwordx4 v[132:135], v3, s[40:41] offset:-3072 sc1
  global_load_dwordx4 v[136:139], v3, s[40:41] offset:-2048 sc1
  global_load_dwordx4 v[140:143], v3, s[40:41] offset:-1024 sc1
  global_load_dwordx4 v[144:147], v3, s[40:41] offset:0 sc1
  global_load_dwordx4 v[148:151], v3, s[40:41] offset:1024 sc1
  global_load_dwordx4 v[152:155], v3, s[40:41] offset:2048 sc1
  global_load_dwordx4 v[156:159], v3, s[40:41] offset:3072 sc1
  s_waitcnt vmcnt(7)
  v_xor_b32 v128, v128, v60
  v_xor_b32 v129, v129, v61
  v_xor_b32 v130, v130, v62
  v_xor_b32 v131, v131, v63
  v_or_b32 v4, v128, v129
  v_or_b32 v5, v130, v131
  s_waitcnt vmcnt(6)
  v_xor_b32 v132, v132, v60
  v_xor_b32 v133, v133, v61
  v_xor_b32 v134, v134, v62
  v_xor_b32 v135, v135, v63
  v_or3_b32 v4, v4, v132, v133
  v_or3_b32 v5, v5, v134, v135
  v_pk_add_f32 v[128:129], v[128:129], v[132:133]
  v_pk_add_f32 v[130:131], v[130:131], v[134:135]
  s_waitcnt vmcnt(5)
  v_xor_b32 v136, v136, v60
  v_xor_b32 v137, v137, v61
  v_xor_b32 v138, v138, v62
  v_xor_b32 v139, v139, v63
  v_or3_b32 v4, v4, v136, v137
  v_or3_b32 v5, v5, v138, v139
  v_pk_add_f32 v[128:129], v[128:129], v[136:137]
  v_pk_add_f32 v[130:131], v[130:131], v[138:139]
  s_waitcnt vmcnt(4)
  v_xor_b32 v140, v140, v60
  v_xor_b32 v141, v141, v61
  v_xor_b32 v142, v142, v62
  v_xor_b32 v143, v143, v63
  v_or3_b32 v4, v4, v140, v141
  v_or3_b32 v5, v5, v142, v143
  v_pk_add_f32 v[128:129], v[128:129], v[140:141]
  v_pk_add_f32 v[130:131], v[130:131], v[142:143]
  s_waitcnt vmcnt(3)
  v_xor_b32 v144, v144, v60
  v_xor_b32 v145, v145, v61
  v_xor_b32 v146, v146, v62
  v_xor_b32 v147, v147, v63
  v_or3_b32 v4, v4, v144, v145
  v_or3_b32 v5, v5, v146, v147
  v_pk_add_f32 v[128:129], v[128:129], v[144:145]
  v_pk_add_f32 v[130:131], v[130:131], v[146:147]
  s_waitcnt vmcnt(2)
  v_xor_b32 v148, v148, v60
  v_xor_b32 v149, v149, v61
  v_xor_b32 v150, v150, v62
  v_xor_b32 v151, v151, v63
  v_or3_b32 v4, v4, v148, v149
  v_or3_b32 v5, v5, v150, v151
  v_pk_add_f32 v[128:129], v[128:129], v[148:149]
  v_pk_add_f32 v[130:131], v[130:131], v[150:151]
  s_waitcnt vmcnt(1)
  v_xor_b32 v152, v152, v60
  v_xor_b32 v153, v153, v61
  v_xor_b32 v154, v154, v62
  v_xor_b32 v155, v155, v63
  v_or3_b32 v4, v4, v152, v153
  v_or3_b32 v5, v5, v154, v155
  v_pk_add_f32 v[128:129], v[128:129], v[152:153]
  v_pk_add_f32 v[130:131], v[130:131], v[154:155]
  s_waitcnt vmcnt(0)
  v_xor_b32 v156, v156, v60
  v_xor_b32 v157, v157, v61
  v_xor_b32 v158, v158, v62
  v_xor_b32 v159, v159, v63
  v_or3_b32 v4, v4, v156, v157
  v_or3_b32 v5, v5, v158, v159
  v_pk_add_f32 v[128:129], v[128:129], v[156:157]
  v_pk_add_f32 v[130:131], v[130:131], v[158:159]
  v_or_b32 v4, v4, v5
  v_and_b32 v4, 0xff, v4
  v_cmp_ne_u32 vcc, 0, v4
  s_cbranch_vccz L_l2d_814
  s_sub_u32 s35, s35, 1
  s_cbranch_scc0 L_l2_813
L_l2d_814:
  v_permlane32_swap_b32 v128, v130
  v_permlane32_swap_b32 v129, v131
  v_pk_add_f32 v[128:129], v[128:129], v[130:131]
  s_nop 1
  v_permlane16_swap_b32 v128, v129
  v_add_f32 v128, v128, v129
  s_nop 1
  v_add_f32_dpp v128, v128, v128 row_ror:4 row_mask:0xf bank_mask:0xf
  s_nop 1
  v_add_f32_dpp v128, v128, v128 row_ror:8 row_mask:0xf bank_mask:0xf
  v_cvt_pk_bf16_f32 v8, v128, v128
  s_mov_b32 exec_lo, 0x000f000f
  s_mov_b32 exec_hi, 0x000f000f
  global_store_short v7, v8, s[24:25]
L_cdone:
L_end:
  s_endpgm
.section .rodata,"a"
.p2align 6
.amdhsa_kernel concat_heads__gqa_block_cached__sliding_block_cached__decode_kernel
  .amdhsa_next_free_vgpr 255
  .amdhsa_next_free_sgpr 102
  .amdhsa_accum_offset 256
  .amdhsa_group_segment_fixed_size 0
  .amdhsa_kernarg_size 104
  .amdhsa_user_sgpr_count 2
  .amdhsa_user_sgpr_kernarg_segment_ptr 1
  .amdhsa_system_sgpr_workgroup_id_x 1
  .amdhsa_float_denorm_mode_32 3
.end_amdhsa_kernel
```
